```python
import torch

def _softmax(x, axis=-1):
    return torch.softmax(x, dim=axis)
def _gelu(x):
    return torch.nn.functional.gelu(x, approximate="tanh")
def _silu(x):
    return torch.nn.functional.silu(x)
def _sigmoid(x):
    return torch.sigmoid(x)
def _layernorm(x, axis=-1, eps=1e-5):
    m = x.mean(dim=axis, keepdim=True)
    v = x.var(dim=axis, keepdim=True, unbiased=False)
    return (x - m) / torch.sqrt(v + eps)
def _scatter_add(tgt, idx, src, axis=0):
    return tgt.clone().index_add_(axis, idx, src)
def _segment_sum(src, seg, n):
    out = torch.zeros((n,) + src.shape[1:], dtype=src.dtype)
    return out.index_add_(0, seg, src)
def _pad(x, pw):
    flat = tuple(v for pair in reversed(pw) for v in pair)
    return torch.nn.functional.pad(x, flat)

kernel_name = 'standalone__mha_block_cached__near_ridge'

def setup_inputs():

    _w = (lambda a: (lambda t: t.to(torch.bfloat16) if t.is_floating_point() else t)(torch.as_tensor(a)))
    B, Sq, D = 16, 32, 640
    H, Sk, Dh = 32, 32, 192
    return {
        "x": _w((lambda *s: torch.randn(*s, dtype=torch.bfloat16) * 0.8)(B, Sq, D)),
        "k_cache": _w((lambda *s: torch.randn(*s, dtype=torch.bfloat16) * 0.8)(B, H, Sk, Dh)),
        "v_cache": _w((lambda *s: torch.randn(*s, dtype=torch.bfloat16) * 0.05)(B, H, Sk, Dh)),
        "wq": _w((lambda *s: torch.randn(*s, dtype=torch.bfloat16) * 0.8)(D, H * Dh) * (D ** -0.5)),
        "wo": _w((lambda *s: torch.randn(*s, dtype=torch.bfloat16) * 0.05)(H * Dh, D) * ((H * Dh) ** -0.5)),
    }

def reference(x, k_cache, v_cache, wq, wo):
    B, Sq, D = x.shape
    H, Dh = 32, 192
    q = (lambda x, *d: x.permute(*d))((x @ wq).reshape(B, Sq, H, Dh), 0, 2, 1, 3)
    scores = torch.einsum("bhqd,bhkd->bhqk", q, k_cache) * (Dh ** -0.5)
    p = _softmax(scores, axis=-1)
    o = torch.einsum("bhqk,bhkd->bhqd", p, v_cache)
    return (lambda x, *d: x.permute(*d))(o, 0, 2, 1, 3).reshape(B, Sq, H * Dh) @ wo
```

```asm
; @launch grid=(256,1,1) block=(512,1,1) lds=163840
.amdgcn_target "amdgcn-amd-amdhsa--gfx950"
.text
.globl standalone__mha_block_cached__near_ridge_kernel
.p2align 8
.type standalone__mha_block_cached__near_ridge_kernel,@function
standalone__mha_block_cached__near_ridge_kernel:
L_start:
    s_cmp_ge_u32 s2, 256
    s_cbranch_scc1 L_end
    s_load_dwordx16 s[4:19], s[0:1], 0
    v_lshrrev_b32 v1, 6, v0
    v_and_b32 v0, 63, v0
    v_readfirstlane_b32 s3, v1
    s_and_b32 s23, s2, 7
    s_bfe_u32 s22, s2, 0x20003
    s_lshr_b32 s21, s2, 5
    s_lshl_b32 s20, s23, 2
    s_add_u32 s20, s20, s22
    s_lshr_b32 s70, s2, 6
    s_and_b32 s71, s21, 1
    s_movk_i32 s75, 0x180
    s_mov_b32 s78, 4194304
    s_cmp_ge_u32 s3, 2
    s_cbranch_scc1 L_notload
    s_setprio 1
    v_and_b32 v5, 31, v0
    s_lshl_b32 s73, s3, 2
    v_lshl_add_u32 v5, v5, 3, s73
    v_bfrev_b32 v47, 2
    ds_write_b32 v5, v47
    s_movk_i32 s74, 0x3000
    v_mul_u32_u24 v6, 0xAAAB, v0
    v_lshrrev_b32 v6, 20, v6
    v_mul_u32_u24 v7, 24, v6
    v_sub_u32 v7, v0, v7
    v_lshlrev_b32 v8, 1, v6
    v_and_b32 v8, 4, v8
    v_xor_b32 v7, v7, v8
    v_lshlrev_b32 v7, 4, v7
    v_mad_u32_u24 v10, v6, s74, v7
    v_add_u32 v5, 64, v0
    v_mul_u32_u24 v6, 0xAAAB, v5
    v_lshrrev_b32 v6, 20, v6
    v_mul_u32_u24 v7, 24, v6
    v_sub_u32 v7, v5, v7
    v_lshlrev_b32 v8, 1, v6
    v_and_b32 v8, 4, v8
    v_xor_b32 v7, v7, v8
    v_lshlrev_b32 v7, 4, v7
    v_subrev_u32 v7, 1024, v7
    v_mad_u32_u24 v11, v6, s74, v7
    v_add_u32 v5, 128, v0
    v_mul_u32_u24 v6, 0xAAAB, v5
    v_lshrrev_b32 v6, 20, v6
    v_mul_u32_u24 v7, 24, v6
    v_sub_u32 v7, v5, v7
    v_lshlrev_b32 v8, 1, v6
    v_and_b32 v8, 4, v8
    v_xor_b32 v7, v7, v8
    v_lshlrev_b32 v7, 4, v7
    v_subrev_u32 v7, 2048, v7
    v_mad_u32_u24 v12, v6, s74, v7
    s_movk_i32 s74, 1280
    v_lshrrev_b32 v2, 3, v0
    v_and_b32 v1, 7, v0
    v_lshrrev_b32 v7, 4, v0
    v_xor_b32 v3, v1, v7
    v_lshlrev_b32 v3, 4, v3
    v_xor_b32 v4, 64, v3
    v_mad_u32_u24 v13, v2, s74, v3
    v_mad_u32_u24 v14, v2, s74, v4
    v_add_u32 v14, 9216, v14
    v_add_u32 v15, 18432, v13
    v_add_u32 v16, 18432, v14
    s_add_u32 s56, s70, s22
    s_mul_i32 s57, s71, 10
    s_add_u32 s57, s57, s3
    s_mul_i32 s57, s57, 32*12288
    s_mul_i32 s61, s20, 384
    s_add_u32 s57, s57, s61
    s_lshl_b32 s58, s70, 1
    s_add_u32 s58, s58, s3
    s_lshl_b32 s58, s58, 7
    s_add_u32 s58, s58, s71
    s_mul_i32 s58, s58, 640
    s_mul_i32 s59, s3, 12288
    s_lshl_b32 s60, s3, 13
    s_mov_b32 s26, 655360
    s_mov_b32 s27, 0x20000
    s_mov_b32 s38, 7864320
    s_mov_b32 s39, 0x20000
    s_waitcnt lgkmcnt(0)
    s_mov_b64 s[36:37], s[10:11]
    s_mov_b64 s[24:25], s[4:5]
    s_mul_i32 s61, 0, 64*12288
    s_add_u32 s61, s61, s57
    s_add_u32 m0, s59, 8192
    s_nop 0
    buffer_load_dwordx4 v10, s[36:39], s61 offen offset:0 lds
    buffer_load_dwordx4 v11, s[36:39], s61 offen offset:1024 lds
    buffer_load_dwordx4 v12, s[36:39], s61 offen offset:2048 lds
    s_add_u32 m0, m0, 3072
    s_add_u32 s61, s61, 8*12288
    buffer_load_dwordx4 v10, s[36:39], s61 offen offset:0 lds
    buffer_load_dwordx4 v11, s[36:39], s61 offen offset:1024 lds
    buffer_load_dwordx4 v12, s[36:39], s61 offen offset:2048 lds
    s_add_u32 m0, m0, 3072
    s_add_u32 s61, s61, 8*12288
    buffer_load_dwordx4 v10, s[36:39], s61 offen offset:0 lds
    buffer_load_dwordx4 v11, s[36:39], s61 offen offset:1024 lds
    buffer_load_dwordx4 v12, s[36:39], s61 offen offset:2048 lds
    s_add_u32 m0, m0, 3072
    s_add_u32 s61, s61, 8*12288
    buffer_load_dwordx4 v10, s[36:39], s61 offen offset:0 lds
    buffer_load_dwordx4 v11, s[36:39], s61 offen offset:1024 lds
    buffer_load_dwordx4 v12, s[36:39], s61 offen offset:2048 lds
    s_lshl_b32 s61, 0, 7
    s_add_u32 s61, s61, s58
    s_add_u32 m0, s60, 32768
    s_nop 0
    buffer_load_dwordx4 v13, s[24:27], s61 offen offset:0 lds
    buffer_load_dwordx4 v14, s[24:27], s61 offen offset:1024 lds
    buffer_load_dwordx4 v15, s[24:27], s61 offen offset:2048 lds
    buffer_load_dwordx4 v16, s[24:27], s61 offen offset:3072 lds
    s_add_u32 m0, m0, 4096
    s_add_u32 s61, s61, 32*1280
    buffer_load_dwordx4 v13, s[24:27], s61 offen offset:0 lds
    buffer_load_dwordx4 v14, s[24:27], s61 offen offset:1024 lds
    buffer_load_dwordx4 v15, s[24:27], s61 offen offset:2048 lds
    buffer_load_dwordx4 v16, s[24:27], s61 offen offset:3072 lds
    s_mov_b32 m0, s73
    s_mov_b64 exec, 1
    buffer_load_dword v47, s[24:27], 0 offen offset:0 lds
    s_mov_b64 exec, -1
    s_barrier
    v_mad_u32_u24 v25, v2, s75, v3
    v_mad_u32_u24 v26, v2, s75, v4
    v_add_u32 v26, 2048, v26
    v_add_u32 v27, 4096, v25
    v_add_u32 v28, 4096, v26
    s_mov_b32 s30, 6291456
    s_mov_b32 s31, 0x20000
    s_mov_b32 s34, 6291456
    s_mov_b32 s35, 0x20000
    s_mov_b32 s42, 7864320
    s_mov_b32 s43, 0x20000
    s_mov_b64 s[28:29], s[6:7]
    s_mov_b64 s[32:33], s[8:9]
    s_mov_b64 s[40:41], s[12:13]
    s_lshl_b32 s65, s70, 1
    s_add_u32 s65, s65, s3
    s_lshl_b32 s65, s65, 6
    s_add_u32 s65, s65, s20
    s_mul_i32 s65, s65, 12288
    s_bitcmp1_b32 s21, 0
    s_cbranch_scc1 L_ldB
    s_add_u32 s63, s56, 1
    s_and_b32 s63, s63, 3
    s_add_u32 s63, s63, 1
    s_mul_i32 s61, s63, 64*12288
    s_add_u32 s61, s61, s57
    s_add_u32 m0, s59, 57344
    s_nop 0
    buffer_load_dwordx4 v10, s[36:39], s61 offen offset:0 lds
    buffer_load_dwordx4 v11, s[36:39], s61 offen offset:1024 lds
    buffer_load_dwordx4 v12, s[36:39], s61 offen offset:2048 lds
    s_add_u32 m0, m0, 3072
    s_add_u32 s61, s61, 8*12288
    buffer_load_dwordx4 v10, s[36:39], s61 offen offset:0 lds
    buffer_load_dwordx4 v11, s[36:39], s61 offen offset:1024 lds
    buffer_load_dwordx4 v12, s[36:39], s61 offen offset:2048 lds
    s_add_u32 m0, m0, 3072
    s_add_u32 s61, s61, 8*12288
    buffer_load_dwordx4 v10, s[36:39], s61 offen offset:0 lds
    buffer_load_dwordx4 v11, s[36:39], s61 offen offset:1024 lds
    buffer_load_dwordx4 v12, s[36:39], s61 offen offset:2048 lds
    s_add_u32 m0, m0, 3072
    s_add_u32 s61, s61, 8*12288
    buffer_load_dwordx4 v10, s[36:39], s61 offen offset:0 lds
    buffer_load_dwordx4 v11, s[36:39], s61 offen offset:1024 lds
    buffer_load_dwordx4 v12, s[36:39], s61 offen offset:2048 lds
    s_add_u32 s63, s56, 1
    s_and_b32 s63, s63, 3
    s_add_u32 s63, s63, 1
    s_lshl_b32 s61, s63, 7
    s_add_u32 s61, s61, s58
    s_add_u32 m0, s60, 81920
    s_nop 0
    buffer_load_dwordx4 v13, s[24:27], s61 offen offset:0 lds
    buffer_load_dwordx4 v14, s[24:27], s61 offen offset:1024 lds
    buffer_load_dwordx4 v15, s[24:27], s61 offen offset:2048 lds
    buffer_load_dwordx4 v16, s[24:27], s61 offen offset:3072 lds
    s_add_u32 m0, m0, 4096
    s_add_u32 s61, s61, 32*1280
    buffer_load_dwordx4 v13, s[24:27], s61 offen offset:0 lds
    buffer_load_dwordx4 v14, s[24:27], s61 offen offset:1024 lds
    buffer_load_dwordx4 v15, s[24:27], s61 offen offset:2048 lds
    buffer_load_dwordx4 v16, s[24:27], s61 offen offset:3072 lds
    v_lshlrev_b32 v7, 2, v7
    v_and_b32 v7, 4, v7
    v_xor_b32 v7, v7, v1
    v_lshlrev_b32 v7, 4, v7
    v_mad_u32_u24 v20, v2, s74, v7
    v_add_u32 v21, 9216, v20
    v_add_u32 v22, 18432, v20
    v_add_u32 v23, 27648, v20
    v_and_b32 v5, 31, v0
    v_lshrrev_b32 v6, 5, v0
    v_lshlrev_b32 v6, 7, v6
    v_mad_u32_u24 v30, v5, s75, v6
    v_mad_u32_u24 v31, v5, s74, v6
    v_mov_b32 v9, 0
    s_lshl_b32 s66, s3, 12
    s_lshr_b32 s61, s22, 1
    s_mul_i32 s67, s61, 640
    s_and_b32 s61, s22, 1
    s_mul_i32 s62, s61, 384
    s_add_u32 s67, s67, s62
    s_sub_u32 s68, 256, s62
    s_mul_i32 s62, s3, 32*1280
    s_add_u32 s67, s67, s62
    s_lshl_b32 s69, s21, 1
    s_add_u32 s69, s69, s3
    s_mul_i32 s69, s69, 393216
    s_and_b32 s63, s20, -4
    s_add_u32 s72, s22, s70
    s_add_u32 s61, s72, 0
    s_and_b32 s61, s61, 3
    s_add_u32 s61, s61, s63
    s_mul_i32 s44, s61, 192*1280
    s_add_u32 s44, s44, s67
    s_mul_i32 s50, s61, 12288
    s_add_u32 s50, s50, s69
    s_add_u32 s61, s72, 1
    s_and_b32 s61, s61, 3
    s_add_u32 s61, s61, s63
    s_mul_i32 s45, s61, 192*1280
    s_add_u32 s45, s45, s67
    s_mul_i32 s51, s61, 12288
    s_add_u32 s51, s51, s69
    s_add_u32 s61, s72, 2
    s_and_b32 s61, s61, 3
    s_add_u32 s61, s61, s63
    s_mul_i32 s46, s61, 192*1280
    s_add_u32 s46, s46, s67
    s_mul_i32 s52, s61, 12288
    s_add_u32 s52, s52, s69
    s_add_u32 s61, s72, 3
    s_and_b32 s61, s61, 3
    s_add_u32 s61, s61, s63
    s_mul_i32 s47, s61, 192*1280
    s_add_u32 s47, s47, s67
    s_mul_i32 s53, s61, 12288
    s_add_u32 s53, s53, s69
    s_add_u32 s48, s44, s68
    s_add_u32 s49, s46, s68
    s_mov_b32 m0, s73
    s_mov_b64 exec, 1
    buffer_load_dword v47, s[24:27], 0 offen offset:8 lds
    s_mov_b64 exec, -1
    s_barrier
    s_add_u32 s63, s56, 2
    s_and_b32 s63, s63, 3
    s_add_u32 s63, s63, 1
    s_mul_i32 s61, s63, 64*12288
    s_add_u32 s61, s61, s57
    s_add_u32 m0, s59, 98304
    s_nop 0
    buffer_load_dwordx4 v10, s[36:39], s61 offen offset:0 lds
    buffer_load_dwordx4 v11, s[36:39], s61 offen offset:1024 lds
    buffer_load_dwordx4 v12, s[36:39], s61 offen offset:2048 lds
    s_add_u32 m0, m0, 3072
    s_add_u32 s61, s61, 8*12288
    buffer_load_dwordx4 v10, s[36:39], s61 offen offset:0 lds
    buffer_load_dwordx4 v11, s[36:39], s61 offen offset:1024 lds
    buffer_load_dwordx4 v12, s[36:39], s61 offen offset:2048 lds
    s_add_u32 m0, m0, 3072
    s_add_u32 s61, s61, 8*12288
    buffer_load_dwordx4 v10, s[36:39], s61 offen offset:0 lds
    buffer_load_dwordx4 v11, s[36:39], s61 offen offset:1024 lds
    buffer_load_dwordx4 v12, s[36:39], s61 offen offset:2048 lds
    s_add_u32 m0, m0, 3072
    s_add_u32 s61, s61, 8*12288
    buffer_load_dwordx4 v10, s[36:39], s61 offen offset:0 lds
    buffer_load_dwordx4 v11, s[36:39], s61 offen offset:1024 lds
    buffer_load_dwordx4 v12, s[36:39], s61 offen offset:2048 lds
    s_add_u32 s63, s56, 2
    s_and_b32 s63, s63, 3
    s_add_u32 s63, s63, 1
    s_lshl_b32 s61, s63, 7
    s_add_u32 s61, s61, s58
    s_add_u32 m0, s60, 122880
    s_nop 0
    buffer_load_dwordx4 v13, s[24:27], s61 offen offset:0 lds
    buffer_load_dwordx4 v14, s[24:27], s61 offen offset:1024 lds
    buffer_load_dwordx4 v15, s[24:27], s61 offen offset:2048 lds
    buffer_load_dwordx4 v16, s[24:27], s61 offen offset:3072 lds
    s_add_u32 m0, m0, 4096
    s_add_u32 s61, s61, 32*1280
    buffer_load_dwordx4 v13, s[24:27], s61 offen offset:0 lds
    buffer_load_dwordx4 v14, s[24:27], s61 offen offset:1024 lds
    buffer_load_dwordx4 v15, s[24:27], s61 offen offset:2048 lds
    buffer_load_dwordx4 v16, s[24:27], s61 offen offset:3072 lds
    s_mov_b32 m0, s73
    s_mov_b64 exec, 1
    buffer_load_dword v47, s[24:27], 0 offen offset:16 lds
    s_mov_b64 exec, -1
    s_cmp_eq_u32 s3, 0
    s_cselect_b32 s61, 34, 2
    s_lshl_b32 m0, s61, 12
    s_add_u32 s61, s65, 0
    buffer_load_dwordx4 v25, s[28:31], s61 offen offset:0 lds
    buffer_load_dwordx4 v26, s[28:31], s61 offen offset:1024 lds
    buffer_load_dwordx4 v27, s[28:31], s61 offen offset:2048 lds
    buffer_load_dwordx4 v28, s[28:31], s61 offen offset:3072 lds
    s_add_u32 m0, m0, 4096
    s_add_u32 s61, s65, 128
    buffer_load_dwordx4 v25, s[28:31], s61 offen offset:0 lds
    buffer_load_dwordx4 v26, s[28:31], s61 offen offset:1024 lds
    buffer_load_dwordx4 v27, s[28:31], s61 offen offset:2048 lds
    buffer_load_dwordx4 v28, s[28:31], s61 offen offset:3072 lds
    s_add_u32 m0, m0, 4096
    s_add_u32 s61, s65, 256
    buffer_load_dwordx4 v25, s[28:31], s61 offen offset:0 lds
    buffer_load_dwordx4 v26, s[28:31], s61 offen offset:1024 lds
    buffer_load_dwordx4 v27, s[28:31], s61 offen offset:2048 lds
    buffer_load_dwordx4 v28, s[28:31], s61 offen offset:3072 lds
    s_barrier
    s_cmp_eq_u32 s3, 0
    s_cselect_b32 s61, 37, 5
    s_lshl_b32 m0, s61, 12
    s_add_u32 s61, s65, 393216
    buffer_load_dwordx4 v25, s[28:31], s61 offen offset:0 lds
    buffer_load_dwordx4 v26, s[28:31], s61 offen offset:1024 lds
    buffer_load_dwordx4 v27, s[28:31], s61 offen offset:2048 lds
    buffer_load_dwordx4 v28, s[28:31], s61 offen offset:3072 lds
    s_add_u32 m0, m0, 4096
    s_add_u32 s61, s65, 393344
    buffer_load_dwordx4 v25, s[28:31], s61 offen offset:0 lds
    buffer_load_dwordx4 v26, s[28:31], s61 offen offset:1024 lds
    buffer_load_dwordx4 v27, s[28:31], s61 offen offset:2048 lds
    buffer_load_dwordx4 v28, s[28:31], s61 offen offset:3072 lds
    s_add_u32 m0, m0, 4096
    s_add_u32 s61, s65, 393472
    buffer_load_dwordx4 v25, s[28:31], s61 offen offset:0 lds
    buffer_load_dwordx4 v26, s[28:31], s61 offen offset:1024 lds
    buffer_load_dwordx4 v27, s[28:31], s61 offen offset:2048 lds
    buffer_load_dwordx4 v28, s[28:31], s61 offen offset:3072 lds
    s_mov_b32 m0, s73
    s_mov_b64 exec, 1
    buffer_load_dword v47, s[24:27], 0 offen offset:40 lds
    s_mov_b64 exec, -1
    s_barrier
    s_add_u32 s63, s56, 3
    s_and_b32 s63, s63, 3
    s_add_u32 s63, s63, 1
    s_mul_i32 s61, s63, 64*12288
    s_add_u32 s61, s61, s57
    s_add_u32 m0, s59, 32768
    s_nop 0
    buffer_load_dwordx4 v10, s[36:39], s61 offen offset:0 lds
    buffer_load_dwordx4 v11, s[36:39], s61 offen offset:1024 lds
    buffer_load_dwordx4 v12, s[36:39], s61 offen offset:2048 lds
    s_add_u32 m0, m0, 3072
    s_add_u32 s61, s61, 8*12288
    buffer_load_dwordx4 v10, s[36:39], s61 offen offset:0 lds
    buffer_load_dwordx4 v11, s[36:39], s61 offen offset:1024 lds
    buffer_load_dwordx4 v12, s[36:39], s61 offen offset:2048 lds
    s_add_u32 m0, m0, 3072
    s_add_u32 s61, s61, 8*12288
    buffer_load_dwordx4 v10, s[36:39], s61 offen offset:0 lds
    buffer_load_dwordx4 v11, s[36:39], s61 offen offset:1024 lds
    buffer_load_dwordx4 v12, s[36:39], s61 offen offset:2048 lds
    s_add_u32 m0, m0, 3072
    s_add_u32 s61, s61, 8*12288
    buffer_load_dwordx4 v10, s[36:39], s61 offen offset:0 lds
    buffer_load_dwordx4 v11, s[36:39], s61 offen offset:1024 lds
    buffer_load_dwordx4 v12, s[36:39], s61 offen offset:2048 lds
    s_add_u32 s63, s56, 3
    s_and_b32 s63, s63, 3
    s_add_u32 s63, s63, 1
    s_lshl_b32 s61, s63, 7
    s_add_u32 s61, s61, s58
    s_add_u32 m0, s60, 57344
    s_nop 0
    buffer_load_dwordx4 v13, s[24:27], s61 offen offset:0 lds
    buffer_load_dwordx4 v14, s[24:27], s61 offen offset:1024 lds
    buffer_load_dwordx4 v15, s[24:27], s61 offen offset:2048 lds
    buffer_load_dwordx4 v16, s[24:27], s61 offen offset:3072 lds
    s_add_u32 m0, m0, 4096
    s_add_u32 s61, s61, 32*1280
    buffer_load_dwordx4 v13, s[24:27], s61 offen offset:0 lds
    buffer_load_dwordx4 v14, s[24:27], s61 offen offset:1024 lds
    buffer_load_dwordx4 v15, s[24:27], s61 offen offset:2048 lds
    buffer_load_dwordx4 v16, s[24:27], s61 offen offset:3072 lds
    s_mov_b32 m0, s73
    s_mov_b64 exec, 1
    buffer_load_dword v47, s[24:27], 0 offen offset:24 lds
    s_mov_b64 exec, -1
    s_add_u32 s63, s56, 4
    s_and_b32 s63, s63, 3
    s_add_u32 s63, s63, 1
    s_mul_i32 s61, s63, 64*12288
    s_add_u32 s61, s61, s57
    s_add_u32 m0, s59, 73728
    s_nop 0
    buffer_load_dwordx4 v10, s[36:39], s61 offen offset:0 lds
    buffer_load_dwordx4 v11, s[36:39], s61 offen offset:1024 lds
    buffer_load_dwordx4 v12, s[36:39], s61 offen offset:2048 lds
    s_add_u32 m0, m0, 3072
    s_add_u32 s61, s61, 8*12288
    buffer_load_dwordx4 v10, s[36:39], s61 offen offset:0 lds
    buffer_load_dwordx4 v11, s[36:39], s61 offen offset:1024 lds
    buffer_load_dwordx4 v12, s[36:39], s61 offen offset:2048 lds
    s_add_u32 m0, m0, 3072
    s_add_u32 s61, s61, 8*12288
    buffer_load_dwordx4 v10, s[36:39], s61 offen offset:0 lds
    buffer_load_dwordx4 v11, s[36:39], s61 offen offset:1024 lds
    buffer_load_dwordx4 v12, s[36:39], s61 offen offset:2048 lds
    s_add_u32 m0, m0, 3072
    s_add_u32 s61, s61, 8*12288
    buffer_load_dwordx4 v10, s[36:39], s61 offen offset:0 lds
    buffer_load_dwordx4 v11, s[36:39], s61 offen offset:1024 lds
    buffer_load_dwordx4 v12, s[36:39], s61 offen offset:2048 lds
    s_add_u32 s63, s56, 4
    s_and_b32 s63, s63, 3
    s_add_u32 s63, s63, 1
    s_lshl_b32 s61, s63, 7
    s_add_u32 s61, s61, s58
    s_add_u32 m0, s60, 98304
    s_nop 0
    buffer_load_dwordx4 v13, s[24:27], s61 offen offset:0 lds
    buffer_load_dwordx4 v14, s[24:27], s61 offen offset:1024 lds
    buffer_load_dwordx4 v15, s[24:27], s61 offen offset:2048 lds
    buffer_load_dwordx4 v16, s[24:27], s61 offen offset:3072 lds
    s_add_u32 m0, m0, 4096
    s_add_u32 s61, s61, 32*1280
    buffer_load_dwordx4 v13, s[24:27], s61 offen offset:0 lds
    buffer_load_dwordx4 v14, s[24:27], s61 offen offset:1024 lds
    buffer_load_dwordx4 v15, s[24:27], s61 offen offset:2048 lds
    buffer_load_dwordx4 v16, s[24:27], s61 offen offset:3072 lds
    s_mov_b32 m0, s73
    s_mov_b64 exec, 1
    buffer_load_dword v47, s[24:27], 0 offen offset:32 lds
    s_mov_b64 exec, -1
    s_add_u32 m0, s66, 114688
    s_add_u32 s61, s50, 0
    buffer_load_dwordx4 v25, s[32:35], s61 offen offset:0 lds
    buffer_load_dwordx4 v26, s[32:35], s61 offen offset:1024 lds
    buffer_load_dwordx4 v27, s[32:35], s61 offen offset:2048 lds
    buffer_load_dwordx4 v28, s[32:35], s61 offen offset:3072 lds
    s_add_u32 m0, s66, 122880
    s_add_u32 s61, s50, 128
    buffer_load_dwordx4 v25, s[32:35], s61 offen offset:0 lds
    buffer_load_dwordx4 v26, s[32:35], s61 offen offset:1024 lds
    buffer_load_dwordx4 v27, s[32:35], s61 offen offset:2048 lds
    buffer_load_dwordx4 v28, s[32:35], s61 offen offset:3072 lds
    s_barrier
    s_add_u32 m0, s66, 131072
    s_add_u32 s61, s50, 256
    buffer_load_dwordx4 v25, s[32:35], s61 offen offset:0 lds
    buffer_load_dwordx4 v26, s[32:35], s61 offen offset:1024 lds
    buffer_load_dwordx4 v27, s[32:35], s61 offen offset:2048 lds
    buffer_load_dwordx4 v28, s[32:35], s61 offen offset:3072 lds
    s_add_u32 m0, s66, 32768
    s_add_u32 s61, s44, 0
    buffer_load_dwordx4 v20, s[40:43], s61 offen offset:0 lds
    buffer_load_dwordx4 v21, s[40:43], s61 offen offset:1024 lds
    buffer_load_dwordx4 v22, s[40:43], s61 offen offset:2048 lds
    buffer_load_dwordx4 v23, s[40:43], s61 offen offset:3072 lds
    s_add_u32 m0, s66, 40960
    s_add_u32 s61, s44, 128
    buffer_load_dwordx4 v20, s[40:43], s61 offen offset:0 lds
    buffer_load_dwordx4 v21, s[40:43], s61 offen offset:1024 lds
    buffer_load_dwordx4 v22, s[40:43], s61 offen offset:2048 lds
    buffer_load_dwordx4 v23, s[40:43], s61 offen offset:3072 lds
    s_add_u32 m0, s66, 49152
    s_add_u32 s61, s48, 0
    buffer_load_dwordx4 v20, s[40:43], s61 offen offset:0 lds
    buffer_load_dwordx4 v21, s[40:43], s61 offen offset:1024 lds
    buffer_load_dwordx4 v22, s[40:43], s61 offen offset:2048 lds
    buffer_load_dwordx4 v23, s[40:43], s61 offen offset:3072 lds
    s_mov_b32 m0, s73
    s_mov_b64 exec, 1
    buffer_load_dword v47, s[24:27], 0 offen offset:48 lds
    s_mov_b64 exec, -1
    s_barrier
    s_barrier
    s_add_u32 m0, s66, 57344
    s_add_u32 s61, s44, 81920
    buffer_load_dwordx4 v20, s[40:43], s61 offen offset:0 lds
    buffer_load_dwordx4 v21, s[40:43], s61 offen offset:1024 lds
    buffer_load_dwordx4 v22, s[40:43], s61 offen offset:2048 lds
    buffer_load_dwordx4 v23, s[40:43], s61 offen offset:3072 lds
    s_add_u32 m0, s66, 65536
    s_add_u32 s61, s44, 82048
    buffer_load_dwordx4 v20, s[40:43], s61 offen offset:0 lds
    buffer_load_dwordx4 v21, s[40:43], s61 offen offset:1024 lds
    buffer_load_dwordx4 v22, s[40:43], s61 offen offset:2048 lds
    buffer_load_dwordx4 v23, s[40:43], s61 offen offset:3072 lds
    s_add_u32 m0, s66, 73728
    s_add_u32 s61, s48, 81920
    buffer_load_dwordx4 v20, s[40:43], s61 offen offset:0 lds
    buffer_load_dwordx4 v21, s[40:43], s61 offen offset:1024 lds
    buffer_load_dwordx4 v22, s[40:43], s61 offen offset:2048 lds
    buffer_load_dwordx4 v23, s[40:43], s61 offen offset:3072 lds
    s_mov_b32 m0, s73
    s_mov_b64 exec, 1
    buffer_load_dword v47, s[24:27], 0 offen offset:56 lds
    s_mov_b64 exec, -1
    s_add_u32 m0, s66, 81920
    s_add_u32 s61, s44, 163840
    buffer_load_dwordx4 v20, s[40:43], s61 offen offset:0 lds
    buffer_load_dwordx4 v21, s[40:43], s61 offen offset:1024 lds
    buffer_load_dwordx4 v22, s[40:43], s61 offen offset:2048 lds
    buffer_load_dwordx4 v23, s[40:43], s61 offen offset:3072 lds
    s_add_u32 m0, s66, 90112
    s_add_u32 s61, s44, 163968
    buffer_load_dwordx4 v20, s[40:43], s61 offen offset:0 lds
    buffer_load_dwordx4 v21, s[40:43], s61 offen offset:1024 lds
    buffer_load_dwordx4 v22, s[40:43], s61 offen offset:2048 lds
    buffer_load_dwordx4 v23, s[40:43], s61 offen offset:3072 lds
    s_add_u32 m0, s66, 98304
    s_add_u32 s61, s48, 163840
    buffer_load_dwordx4 v20, s[40:43], s61 offen offset:0 lds
    buffer_load_dwordx4 v21, s[40:43], s61 offen offset:1024 lds
    buffer_load_dwordx4 v22, s[40:43], s61 offen offset:2048 lds
    buffer_load_dwordx4 v23, s[40:43], s61 offen offset:3072 lds
    s_mov_b32 m0, s73
    s_mov_b64 exec, 1
    buffer_load_dword v47, s[24:27], 0 offen offset:64 lds
    s_mov_b64 exec, -1
    s_add_u32 m0, s66, 8192
    s_add_u32 s61, s45, 0
    buffer_load_dwordx4 v20, s[40:43], s61 offen offset:0 lds
    buffer_load_dwordx4 v21, s[40:43], s61 offen offset:1024 lds
    buffer_load_dwordx4 v22, s[40:43], s61 offen offset:2048 lds
    buffer_load_dwordx4 v23, s[40:43], s61 offen offset:3072 lds
    s_add_u32 m0, s66, 16384
    s_add_u32 s61, s45, 128
    buffer_load_dwordx4 v20, s[40:43], s61 offen offset:0 lds
    buffer_load_dwordx4 v21, s[40:43], s61 offen offset:1024 lds
    buffer_load_dwordx4 v22, s[40:43], s61 offen offset:2048 lds
    buffer_load_dwordx4 v23, s[40:43], s61 offen offset:3072 lds
    s_add_u32 m0, s66, 24576
    s_add_u32 s61, s51, 0
    buffer_load_dwordx4 v25, s[32:35], s61 offen offset:0 lds
    ds_read_b128 v[40:43], v9 offset:320
    buffer_load_dwordx4 v26, s[32:35], s61 offen offset:1024 lds
    buffer_load_dwordx4 v27, s[32:35], s61 offen offset:2048 lds
    buffer_load_dwordx4 v28, s[32:35], s61 offen offset:3072 lds
    s_mov_b32 m0, s73
    s_mov_b64 exec, 1
    buffer_load_dword v47, s[24:27], 0 offen offset:72 lds
    s_mov_b64 exec, -1
L_w_1:
    s_waitcnt lgkmcnt(0)
    v_xor_b32 v40, 255, v40
    v_cmp_ne_u32 vcc, 0, v40
    s_cbranch_vccz L_w_1_ok
    ds_read_b128 v[40:43], v9 offset:320
    s_add_i32 s78, s78, -1
    s_cmp_gt_i32 s78, 0
    s_cbranch_scc1 L_w_1
L_w_1_ok:
    s_add_u32 m0, s66, 32768
    s_add_u32 s61, s45, 81920
    buffer_load_dwordx4 v20, s[40:43], s61 offen offset:0 lds
    buffer_load_dwordx4 v21, s[40:43], s61 offen offset:1024 lds
    buffer_load_dwordx4 v22, s[40:43], s61 offen offset:2048 lds
    buffer_load_dwordx4 v23, s[40:43], s61 offen offset:3072 lds
    s_add_u32 m0, s66, 40960
    s_add_u32 s61, s45, 82048
    buffer_load_dwordx4 v20, s[40:43], s61 offen offset:0 lds
    buffer_load_dwordx4 v21, s[40:43], s61 offen offset:1024 lds
    buffer_load_dwordx4 v22, s[40:43], s61 offen offset:2048 lds
    buffer_load_dwordx4 v23, s[40:43], s61 offen offset:3072 lds
    s_add_u32 m0, s66, 49152
    s_add_u32 s61, s51, 128
    buffer_load_dwordx4 v25, s[32:35], s61 offen offset:0 lds
    buffer_load_dwordx4 v26, s[32:35], s61 offen offset:1024 lds
    buffer_load_dwordx4 v27, s[32:35], s61 offen offset:2048 lds
    buffer_load_dwordx4 v28, s[32:35], s61 offen offset:3072 lds
    s_mov_b32 m0, s73
    s_mov_b64 exec, 1
    buffer_load_dword v47, s[24:27], 0 offen offset:80 lds
    s_mov_b64 exec, -1
    s_add_u32 m0, s66, 106496
    s_add_u32 s61, s45, 163840
    buffer_load_dwordx4 v20, s[40:43], s61 offen offset:0 lds
    buffer_load_dwordx4 v21, s[40:43], s61 offen offset:1024 lds
    buffer_load_dwordx4 v22, s[40:43], s61 offen offset:2048 lds
    buffer_load_dwordx4 v23, s[40:43], s61 offen offset:3072 lds
    s_add_u32 m0, s66, 114688
    s_add_u32 s61, s45, 163968
    buffer_load_dwordx4 v20, s[40:43], s61 offen offset:0 lds
    buffer_load_dwordx4 v21, s[40:43], s61 offen offset:1024 lds
    buffer_load_dwordx4 v22, s[40:43], s61 offen offset:2048 lds
    buffer_load_dwordx4 v23, s[40:43], s61 offen offset:3072 lds
    s_add_u32 m0, s66, 139264
    s_add_u32 s61, s51, 256
    buffer_load_dwordx4 v25, s[32:35], s61 offen offset:0 lds
    ds_read_b128 v[40:43], v9 offset:336
    buffer_load_dwordx4 v26, s[32:35], s61 offen offset:1024 lds
    buffer_load_dwordx4 v27, s[32:35], s61 offen offset:2048 lds
    buffer_load_dwordx4 v28, s[32:35], s61 offen offset:3072 lds
    s_mov_b32 m0, s73
    s_mov_b64 exec, 1
    buffer_load_dword v47, s[24:27], 0 offen offset:88 lds
    s_mov_b64 exec, -1
L_w_2:
    s_waitcnt lgkmcnt(0)
    v_xor_b32 v40, 255, v40
    v_cmp_ne_u32 vcc, 0, v40
    s_cbranch_vccz L_w_2_ok
    ds_read_b128 v[40:43], v9 offset:336
    s_add_i32 s78, s78, -1
    s_cmp_gt_i32 s78, 0
    s_cbranch_scc1 L_w_2
L_w_2_ok:
    s_add_u32 m0, s66, 57344
    s_add_u32 s61, s46, 0
    buffer_load_dwordx4 v20, s[40:43], s61 offen offset:0 lds
    buffer_load_dwordx4 v21, s[40:43], s61 offen offset:1024 lds
    buffer_load_dwordx4 v22, s[40:43], s61 offen offset:2048 lds
    buffer_load_dwordx4 v23, s[40:43], s61 offen offset:3072 lds
    s_add_u32 m0, s66, 65536
    s_add_u32 s61, s46, 128
    buffer_load_dwordx4 v20, s[40:43], s61 offen offset:0 lds
    buffer_load_dwordx4 v21, s[40:43], s61 offen offset:1024 lds
    buffer_load_dwordx4 v22, s[40:43], s61 offen offset:2048 lds
    buffer_load_dwordx4 v23, s[40:43], s61 offen offset:3072 lds
    s_add_u32 m0, s66, 73728
    s_add_u32 s61, s49, 0
    buffer_load_dwordx4 v20, s[40:43], s61 offen offset:0 lds
    buffer_load_dwordx4 v21, s[40:43], s61 offen offset:1024 lds
    buffer_load_dwordx4 v22, s[40:43], s61 offen offset:2048 lds
    buffer_load_dwordx4 v23, s[40:43], s61 offen offset:3072 lds
    s_add_u32 m0, s66, 122880
    s_add_u32 s61, s52, 0
    buffer_load_dwordx4 v25, s[32:35], s61 offen offset:0 lds
    ds_read_b128 v[40:43], v9 offset:352
    buffer_load_dwordx4 v26, s[32:35], s61 offen offset:1024 lds
    buffer_load_dwordx4 v27, s[32:35], s61 offen offset:2048 lds
    buffer_load_dwordx4 v28, s[32:35], s61 offen offset:3072 lds
    s_mov_b32 m0, s73
    s_mov_b64 exec, 1
    buffer_load_dword v47, s[24:27], 0 offen offset:96 lds
    s_mov_b64 exec, -1
L_w_3:
    s_waitcnt lgkmcnt(0)
    v_xor_b32 v40, 255, v40
    v_cmp_ne_u32 vcc, 0, v40
    s_cbranch_vccz L_w_3_ok
    ds_read_b128 v[40:43], v9 offset:352
    s_add_i32 s78, s78, -1
    s_cmp_gt_i32 s78, 0
    s_cbranch_scc1 L_w_3
L_w_3_ok:
    s_add_u32 m0, s66, 81920
    s_add_u32 s61, s46, 81920
    buffer_load_dwordx4 v20, s[40:43], s61 offen offset:0 lds
    buffer_load_dwordx4 v21, s[40:43], s61 offen offset:1024 lds
    buffer_load_dwordx4 v22, s[40:43], s61 offen offset:2048 lds
    buffer_load_dwordx4 v23, s[40:43], s61 offen offset:3072 lds
    s_add_u32 m0, s66, 90112
    s_add_u32 s61, s46, 82048
    buffer_load_dwordx4 v20, s[40:43], s61 offen offset:0 lds
    buffer_load_dwordx4 v21, s[40:43], s61 offen offset:1024 lds
    buffer_load_dwordx4 v22, s[40:43], s61 offen offset:2048 lds
    buffer_load_dwordx4 v23, s[40:43], s61 offen offset:3072 lds
    s_add_u32 m0, s66, 98304
    s_add_u32 s61, s49, 81920
    buffer_load_dwordx4 v20, s[40:43], s61 offen offset:0 lds
    buffer_load_dwordx4 v21, s[40:43], s61 offen offset:1024 lds
    buffer_load_dwordx4 v22, s[40:43], s61 offen offset:2048 lds
    buffer_load_dwordx4 v23, s[40:43], s61 offen offset:3072 lds
    s_add_u32 m0, s66, 131072
    s_add_u32 s61, s52, 128
    buffer_load_dwordx4 v25, s[32:35], s61 offen offset:0 lds
    ds_read_b128 v[40:43], v9 offset:368
    buffer_load_dwordx4 v26, s[32:35], s61 offen offset:1024 lds
    buffer_load_dwordx4 v27, s[32:35], s61 offen offset:2048 lds
    buffer_load_dwordx4 v28, s[32:35], s61 offen offset:3072 lds
    s_mov_b32 m0, s73
    s_mov_b64 exec, 1
    buffer_load_dword v47, s[24:27], 0 offen offset:104 lds
    s_mov_b64 exec, -1
L_w_4:
    s_waitcnt lgkmcnt(0)
    v_xor_b32 v40, 255, v40
    v_cmp_ne_u32 vcc, 0, v40
    s_cbranch_vccz L_w_4_ok
    ds_read_b128 v[40:43], v9 offset:368
    s_add_i32 s78, s78, -1
    s_cmp_gt_i32 s78, 0
    s_cbranch_scc1 L_w_4
L_w_4_ok:
    s_add_u32 m0, s66, 8192
    s_add_u32 s61, s46, 163840
    buffer_load_dwordx4 v20, s[40:43], s61 offen offset:0 lds
    buffer_load_dwordx4 v21, s[40:43], s61 offen offset:1024 lds
    buffer_load_dwordx4 v22, s[40:43], s61 offen offset:2048 lds
    buffer_load_dwordx4 v23, s[40:43], s61 offen offset:3072 lds
    s_add_u32 m0, s66, 16384
    s_add_u32 s61, s46, 163968
    buffer_load_dwordx4 v20, s[40:43], s61 offen offset:0 lds
    buffer_load_dwordx4 v21, s[40:43], s61 offen offset:1024 lds
    buffer_load_dwordx4 v22, s[40:43], s61 offen offset:2048 lds
    buffer_load_dwordx4 v23, s[40:43], s61 offen offset:3072 lds
    s_add_u32 m0, s66, 24576
    s_add_u32 s61, s49, 163840
    buffer_load_dwordx4 v20, s[40:43], s61 offen offset:0 lds
    ds_read_b128 v[40:43], v9 offset:384
    buffer_load_dwordx4 v21, s[40:43], s61 offen offset:1024 lds
    buffer_load_dwordx4 v22, s[40:43], s61 offen offset:2048 lds
    buffer_load_dwordx4 v23, s[40:43], s61 offen offset:3072 lds
L_w_5:
    s_waitcnt lgkmcnt(0)
    v_xor_b32 v40, 255, v40
    v_cmp_ne_u32 vcc, 0, v40
    s_cbranch_vccz L_w_5_ok
    ds_read_b128 v[40:43], v9 offset:384
    s_add_i32 s78, s78, -1
    s_cmp_gt_i32 s78, 0
    s_cbranch_scc1 L_w_5
L_w_5_ok:
    s_add_u32 m0, s66, 32768
    s_add_u32 s61, s52, 256
    buffer_load_dwordx4 v25, s[32:35], s61 offen offset:0 lds
    buffer_load_dwordx4 v26, s[32:35], s61 offen offset:1024 lds
    buffer_load_dwordx4 v27, s[32:35], s61 offen offset:2048 lds
    buffer_load_dwordx4 v28, s[32:35], s61 offen offset:3072 lds
    s_mov_b32 m0, s73
    s_mov_b64 exec, 1
    buffer_load_dword v47, s[24:27], 0 offen offset:112 lds
    s_mov_b64 exec, -1
    s_add_u32 m0, s66, 40960
    s_add_u32 s61, s47, 0
    buffer_load_dwordx4 v20, s[40:43], s61 offen offset:0 lds
    buffer_load_dwordx4 v21, s[40:43], s61 offen offset:1024 lds
    buffer_load_dwordx4 v22, s[40:43], s61 offen offset:2048 lds
    buffer_load_dwordx4 v23, s[40:43], s61 offen offset:3072 lds
    s_add_u32 m0, s66, 49152
    s_add_u32 s61, s47, 128
    buffer_load_dwordx4 v20, s[40:43], s61 offen offset:0 lds
    ds_read_b128 v[40:43], v9 offset:400
    buffer_load_dwordx4 v21, s[40:43], s61 offen offset:1024 lds
    buffer_load_dwordx4 v22, s[40:43], s61 offen offset:2048 lds
    buffer_load_dwordx4 v23, s[40:43], s61 offen offset:3072 lds
L_w_6:
    s_waitcnt lgkmcnt(0)
    v_xor_b32 v40, 255, v40
    v_cmp_ne_u32 vcc, 0, v40
    s_cbranch_vccz L_w_6_ok
    ds_read_b128 v[40:43], v9 offset:400
    s_add_i32 s78, s78, -1
    s_cmp_gt_i32 s78, 0
    s_cbranch_scc1 L_w_6
L_w_6_ok:
    s_add_u32 m0, s66, 139264
    s_add_u32 s61, s53, 0
    buffer_load_dwordx4 v25, s[32:35], s61 offen offset:0 lds
    buffer_load_dwordx4 v26, s[32:35], s61 offen offset:1024 lds
    buffer_load_dwordx4 v27, s[32:35], s61 offen offset:2048 lds
    buffer_load_dwordx4 v28, s[32:35], s61 offen offset:3072 lds
    s_mov_b32 m0, s73
    s_mov_b64 exec, 1
    buffer_load_dword v47, s[24:27], 0 offen offset:120 lds
    s_mov_b64 exec, -1
    s_add_u32 m0, s66, 106496
    s_add_u32 s61, s47, 81920
    buffer_load_dwordx4 v20, s[40:43], s61 offen offset:0 lds
    buffer_load_dwordx4 v21, s[40:43], s61 offen offset:1024 lds
    buffer_load_dwordx4 v22, s[40:43], s61 offen offset:2048 lds
    buffer_load_dwordx4 v23, s[40:43], s61 offen offset:3072 lds
    s_add_u32 m0, s66, 114688
    s_add_u32 s61, s47, 82048
    buffer_load_dwordx4 v20, s[40:43], s61 offen offset:0 lds
    ds_read_b128 v[40:43], v9 offset:416
    buffer_load_dwordx4 v21, s[40:43], s61 offen offset:1024 lds
    buffer_load_dwordx4 v22, s[40:43], s61 offen offset:2048 lds
    buffer_load_dwordx4 v23, s[40:43], s61 offen offset:3072 lds
L_w_7:
    s_waitcnt lgkmcnt(0)
    v_xor_b32 v40, 255, v40
    v_cmp_ne_u32 vcc, 0, v40
    s_cbranch_vccz L_w_7_ok
    ds_read_b128 v[40:43], v9 offset:416
    s_add_i32 s78, s78, -1
    s_cmp_gt_i32 s78, 0
    s_cbranch_scc1 L_w_7
L_w_7_ok:
    s_add_u32 m0, s66, 57344
    s_add_u32 s61, s53, 128
    buffer_load_dwordx4 v25, s[32:35], s61 offen offset:0 lds
    buffer_load_dwordx4 v26, s[32:35], s61 offen offset:1024 lds
    buffer_load_dwordx4 v27, s[32:35], s61 offen offset:2048 lds
    buffer_load_dwordx4 v28, s[32:35], s61 offen offset:3072 lds
    s_mov_b32 m0, s73
    s_mov_b64 exec, 1
    buffer_load_dword v47, s[24:27], 0 offen offset:128 lds
    s_mov_b64 exec, -1
    s_add_u32 m0, s66, 65536
    s_add_u32 s61, s47, 163840
    buffer_load_dwordx4 v20, s[40:43], s61 offen offset:0 lds
    buffer_load_dwordx4 v21, s[40:43], s61 offen offset:1024 lds
    buffer_load_dwordx4 v22, s[40:43], s61 offen offset:2048 lds
    buffer_load_dwordx4 v23, s[40:43], s61 offen offset:3072 lds
    s_add_u32 m0, s66, 73728
    s_add_u32 s61, s47, 163968
    buffer_load_dwordx4 v20, s[40:43], s61 offen offset:0 lds
    buffer_load_dwordx4 v21, s[40:43], s61 offen offset:1024 lds
    buffer_load_dwordx4 v22, s[40:43], s61 offen offset:2048 lds
    buffer_load_dwordx4 v23, s[40:43], s61 offen offset:3072 lds
    s_add_u32 m0, s66, 122880
    s_add_u32 s61, s53, 256
    buffer_load_dwordx4 v25, s[32:35], s61 offen offset:0 lds
    buffer_load_dwordx4 v26, s[32:35], s61 offen offset:1024 lds
    buffer_load_dwordx4 v27, s[32:35], s61 offen offset:2048 lds
    buffer_load_dwordx4 v28, s[32:35], s61 offen offset:3072 lds
    s_mov_b32 m0, s73
    s_mov_b64 exec, 1
    buffer_load_dword v47, s[24:27], 0 offen offset:136 lds
    s_mov_b64 exec, -1
    s_branch L_ldend
L_ldB:
    s_add_u32 s63, s56, 1
    s_and_b32 s63, s63, 3
    s_add_u32 s63, s63, 1
    s_mul_i32 s61, s63, 64*12288
    s_add_u32 s61, s61, s57
    s_add_u32 m0, s59, 49152
    s_nop 0
    buffer_load_dwordx4 v10, s[36:39], s61 offen offset:0 lds
    buffer_load_dwordx4 v11, s[36:39], s61 offen offset:1024 lds
    buffer_load_dwordx4 v12, s[36:39], s61 offen offset:2048 lds
    s_add_u32 m0, m0, 3072
    s_add_u32 s61, s61, 8*12288
    buffer_load_dwordx4 v10, s[36:39], s61 offen offset:0 lds
    buffer_load_dwordx4 v11, s[36:39], s61 offen offset:1024 lds
    buffer_load_dwordx4 v12, s[36:39], s61 offen offset:2048 lds
    s_add_u32 m0, m0, 3072
    s_add_u32 s61, s61, 8*12288
    buffer_load_dwordx4 v10, s[36:39], s61 offen offset:0 lds
    buffer_load_dwordx4 v11, s[36:39], s61 offen offset:1024 lds
    buffer_load_dwordx4 v12, s[36:39], s61 offen offset:2048 lds
    s_add_u32 m0, m0, 3072
    s_add_u32 s61, s61, 8*12288
    buffer_load_dwordx4 v10, s[36:39], s61 offen offset:0 lds
    buffer_load_dwordx4 v11, s[36:39], s61 offen offset:1024 lds
    buffer_load_dwordx4 v12, s[36:39], s61 offen offset:2048 lds
    s_add_u32 s63, s56, 1
    s_and_b32 s63, s63, 3
    s_add_u32 s63, s63, 1
    s_lshl_b32 s61, s63, 7
    s_add_u32 s61, s61, s58
    s_add_u32 m0, s60, 73728
    s_nop 0
    buffer_load_dwordx4 v13, s[24:27], s61 offen offset:0 lds
    buffer_load_dwordx4 v14, s[24:27], s61 offen offset:1024 lds
    buffer_load_dwordx4 v15, s[24:27], s61 offen offset:2048 lds
    buffer_load_dwordx4 v16, s[24:27], s61 offen offset:3072 lds
    s_add_u32 m0, m0, 4096
    s_add_u32 s61, s61, 32*1280
    buffer_load_dwordx4 v13, s[24:27], s61 offen offset:0 lds
    buffer_load_dwordx4 v14, s[24:27], s61 offen offset:1024 lds
    buffer_load_dwordx4 v15, s[24:27], s61 offen offset:2048 lds
    buffer_load_dwordx4 v16, s[24:27], s61 offen offset:3072 lds
    v_lshlrev_b32 v7, 2, v7
    v_and_b32 v7, 4, v7
    v_xor_b32 v7, v7, v1
    v_lshlrev_b32 v7, 4, v7
    v_mad_u32_u24 v20, v2, s74, v7
    v_add_u32 v21, 9216, v20
    v_add_u32 v22, 18432, v20
    v_add_u32 v23, 27648, v20
    v_and_b32 v5, 31, v0
    v_lshrrev_b32 v6, 5, v0
    v_lshlrev_b32 v6, 7, v6
    v_mad_u32_u24 v30, v5, s75, v6
    v_mad_u32_u24 v31, v5, s74, v6
    v_mov_b32 v9, 0
    s_lshl_b32 s66, s3, 12
    s_lshr_b32 s61, s22, 1
    s_mul_i32 s67, s61, 640
    s_and_b32 s61, s22, 1
    s_mul_i32 s62, s61, 384
    s_add_u32 s67, s67, s62
    s_sub_u32 s68, 256, s62
    s_mul_i32 s62, s3, 32*1280
    s_add_u32 s67, s67, s62
    s_lshl_b32 s69, s21, 1
    s_add_u32 s69, s69, s3
    s_mul_i32 s69, s69, 393216
    s_and_b32 s63, s20, -4
    s_add_u32 s72, s22, s70
    s_add_u32 s61, s72, 0
    s_and_b32 s61, s61, 3
    s_add_u32 s61, s61, s63
    s_mul_i32 s44, s61, 192*1280
    s_add_u32 s44, s44, s67
    s_mul_i32 s50, s61, 12288
    s_add_u32 s50, s50, s69
    s_add_u32 s61, s72, 1
    s_and_b32 s61, s61, 3
    s_add_u32 s61, s61, s63
    s_mul_i32 s45, s61, 192*1280
    s_add_u32 s45, s45, s67
    s_mul_i32 s51, s61, 12288
    s_add_u32 s51, s51, s69
    s_add_u32 s61, s72, 2
    s_and_b32 s61, s61, 3
    s_add_u32 s61, s61, s63
    s_mul_i32 s46, s61, 192*1280
    s_add_u32 s46, s46, s67
    s_mul_i32 s52, s61, 12288
    s_add_u32 s52, s52, s69
    s_add_u32 s61, s72, 3
    s_and_b32 s61, s61, 3
    s_add_u32 s61, s61, s63
    s_mul_i32 s47, s61, 192*1280
    s_add_u32 s47, s47, s67
    s_mul_i32 s53, s61, 12288
    s_add_u32 s53, s53, s69
    s_add_u32 s48, s44, s68
    s_add_u32 s49, s46, s68
    s_mov_b32 m0, s73
    s_mov_b64 exec, 1
    buffer_load_dword v47, s[24:27], 0 offen offset:8 lds
    s_mov_b64 exec, -1
    s_barrier
    s_add_u32 s63, s56, 2
    s_and_b32 s63, s63, 3
    s_add_u32 s63, s63, 1
    s_mul_i32 s61, s63, 64*12288
    s_add_u32 s61, s61, s57
    s_add_u32 m0, s59, 90112
    s_nop 0
    buffer_load_dwordx4 v10, s[36:39], s61 offen offset:0 lds
    buffer_load_dwordx4 v11, s[36:39], s61 offen offset:1024 lds
    buffer_load_dwordx4 v12, s[36:39], s61 offen offset:2048 lds
    s_add_u32 m0, m0, 3072
    s_add_u32 s61, s61, 8*12288
    buffer_load_dwordx4 v10, s[36:39], s61 offen offset:0 lds
    buffer_load_dwordx4 v11, s[36:39], s61 offen offset:1024 lds
    buffer_load_dwordx4 v12, s[36:39], s61 offen offset:2048 lds
    s_add_u32 m0, m0, 3072
    s_add_u32 s61, s61, 8*12288
    buffer_load_dwordx4 v10, s[36:39], s61 offen offset:0 lds
    buffer_load_dwordx4 v11, s[36:39], s61 offen offset:1024 lds
    buffer_load_dwordx4 v12, s[36:39], s61 offen offset:2048 lds
    s_add_u32 m0, m0, 3072
    s_add_u32 s61, s61, 8*12288
    buffer_load_dwordx4 v10, s[36:39], s61 offen offset:0 lds
    buffer_load_dwordx4 v11, s[36:39], s61 offen offset:1024 lds
    buffer_load_dwordx4 v12, s[36:39], s61 offen offset:2048 lds
    s_add_u32 s63, s56, 2
    s_and_b32 s63, s63, 3
    s_add_u32 s63, s63, 1
    s_lshl_b32 s61, s63, 7
    s_add_u32 s61, s61, s58
    s_add_u32 m0, s60, 139264
    s_nop 0
    buffer_load_dwordx4 v13, s[24:27], s61 offen offset:0 lds
    buffer_load_dwordx4 v14, s[24:27], s61 offen offset:1024 lds
    buffer_load_dwordx4 v15, s[24:27], s61 offen offset:2048 lds
    buffer_load_dwordx4 v16, s[24:27], s61 offen offset:3072 lds
    s_add_u32 m0, m0, 4096
    s_add_u32 s61, s61, 32*1280
    buffer_load_dwordx4 v13, s[24:27], s61 offen offset:0 lds
    buffer_load_dwordx4 v14, s[24:27], s61 offen offset:1024 lds
    buffer_load_dwordx4 v15, s[24:27], s61 offen offset:2048 lds
    buffer_load_dwordx4 v16, s[24:27], s61 offen offset:3072 lds
    s_mov_b32 m0, s73
    s_mov_b64 exec, 1
    buffer_load_dword v47, s[24:27], 0 offen offset:16 lds
    s_mov_b64 exec, -1
    s_add_u32 s63, s56, 3
    s_and_b32 s63, s63, 3
    s_add_u32 s63, s63, 1
    s_mul_i32 s61, s63, 64*12288
    s_add_u32 s61, s61, s57
    s_add_u32 m0, s59, 114688
    s_nop 0
    buffer_load_dwordx4 v10, s[36:39], s61 offen offset:0 lds
    buffer_load_dwordx4 v11, s[36:39], s61 offen offset:1024 lds
    buffer_load_dwordx4 v12, s[36:39], s61 offen offset:2048 lds
    s_add_u32 m0, m0, 3072
    s_add_u32 s61, s61, 8*12288
    buffer_load_dwordx4 v10, s[36:39], s61 offen offset:0 lds
    buffer_load_dwordx4 v11, s[36:39], s61 offen offset:1024 lds
    buffer_load_dwordx4 v12, s[36:39], s61 offen offset:2048 lds
    s_add_u32 m0, m0, 3072
    s_add_u32 s61, s61, 8*12288
    buffer_load_dwordx4 v10, s[36:39], s61 offen offset:0 lds
    buffer_load_dwordx4 v11, s[36:39], s61 offen offset:1024 lds
    buffer_load_dwordx4 v12, s[36:39], s61 offen offset:2048 lds
    s_add_u32 m0, m0, 3072
    s_add_u32 s61, s61, 8*12288
    buffer_load_dwordx4 v10, s[36:39], s61 offen offset:0 lds
    buffer_load_dwordx4 v11, s[36:39], s61 offen offset:1024 lds
    buffer_load_dwordx4 v12, s[36:39], s61 offen offset:2048 lds
    s_barrier
    s_add_u32 s63, s56, 3
    s_and_b32 s63, s63, 3
    s_add_u32 s63, s63, 1
    s_lshl_b32 s61, s63, 7
    s_add_u32 s61, s61, s58
    s_add_u32 m0, s60, 8192
    s_nop 0
    buffer_load_dwordx4 v13, s[24:27], s61 offen offset:0 lds
    buffer_load_dwordx4 v14, s[24:27], s61 offen offset:1024 lds
    buffer_load_dwordx4 v15, s[24:27], s61 offen offset:2048 lds
    buffer_load_dwordx4 v16, s[24:27], s61 offen offset:3072 lds
    s_add_u32 m0, m0, 4096
    s_add_u32 s61, s61, 32*1280
    buffer_load_dwordx4 v13, s[24:27], s61 offen offset:0 lds
    buffer_load_dwordx4 v14, s[24:27], s61 offen offset:1024 lds
    buffer_load_dwordx4 v15, s[24:27], s61 offen offset:2048 lds
    buffer_load_dwordx4 v16, s[24:27], s61 offen offset:3072 lds
    s_mov_b32 m0, s73
    s_mov_b64 exec, 1
    buffer_load_dword v47, s[24:27], 0 offen offset:24 lds
    s_mov_b64 exec, -1
    s_add_u32 s63, s56, 4
    s_and_b32 s63, s63, 3
    s_add_u32 s63, s63, 1
    s_mul_i32 s61, s63, 64*12288
    s_add_u32 s61, s61, s57
    s_add_u32 m0, s59, 24576
    s_nop 0
    buffer_load_dwordx4 v10, s[36:39], s61 offen offset:0 lds
    buffer_load_dwordx4 v11, s[36:39], s61 offen offset:1024 lds
    buffer_load_dwordx4 v12, s[36:39], s61 offen offset:2048 lds
    s_add_u32 m0, m0, 3072
    s_add_u32 s61, s61, 8*12288
    buffer_load_dwordx4 v10, s[36:39], s61 offen offset:0 lds
    buffer_load_dwordx4 v11, s[36:39], s61 offen offset:1024 lds
    buffer_load_dwordx4 v12, s[36:39], s61 offen offset:2048 lds
    s_add_u32 m0, m0, 3072
    s_add_u32 s61, s61, 8*12288
    buffer_load_dwordx4 v10, s[36:39], s61 offen offset:0 lds
    buffer_load_dwordx4 v11, s[36:39], s61 offen offset:1024 lds
    buffer_load_dwordx4 v12, s[36:39], s61 offen offset:2048 lds
    s_add_u32 m0, m0, 3072
    s_add_u32 s61, s61, 8*12288
    buffer_load_dwordx4 v10, s[36:39], s61 offen offset:0 lds
    buffer_load_dwordx4 v11, s[36:39], s61 offen offset:1024 lds
    buffer_load_dwordx4 v12, s[36:39], s61 offen offset:2048 lds
    s_add_u32 s63, s56, 4
    s_and_b32 s63, s63, 3
    s_add_u32 s63, s63, 1
    s_lshl_b32 s61, s63, 7
    s_add_u32 s61, s61, s58
    s_add_u32 m0, s60, 49152
    s_nop 0
    buffer_load_dwordx4 v13, s[24:27], s61 offen offset:0 lds
    buffer_load_dwordx4 v14, s[24:27], s61 offen offset:1024 lds
    buffer_load_dwordx4 v15, s[24:27], s61 offen offset:2048 lds
    buffer_load_dwordx4 v16, s[24:27], s61 offen offset:3072 lds
    s_add_u32 m0, m0, 4096
    s_add_u32 s61, s61, 32*1280
    buffer_load_dwordx4 v13, s[24:27], s61 offen offset:0 lds
    buffer_load_dwordx4 v14, s[24:27], s61 offen offset:1024 lds
    buffer_load_dwordx4 v15, s[24:27], s61 offen offset:2048 lds
    buffer_load_dwordx4 v16, s[24:27], s61 offen offset:3072 lds
    s_mov_b32 m0, s73
    s_mov_b64 exec, 1
    buffer_load_dword v47, s[24:27], 0 offen offset:32 lds
    s_mov_b64 exec, -1
    s_barrier
    s_cmp_eq_u32 s3, 0
    s_cselect_b32 s61, 19, 37
    s_lshl_b32 m0, s61, 12
    s_add_u32 s61, s65, 393216
    buffer_load_dwordx4 v25, s[28:31], s61 offen offset:0 lds
    buffer_load_dwordx4 v26, s[28:31], s61 offen offset:1024 lds
    buffer_load_dwordx4 v27, s[28:31], s61 offen offset:2048 lds
    buffer_load_dwordx4 v28, s[28:31], s61 offen offset:3072 lds
    s_add_u32 m0, m0, 4096
    s_add_u32 s61, s65, 393344
    buffer_load_dwordx4 v25, s[28:31], s61 offen offset:0 lds
    buffer_load_dwordx4 v26, s[28:31], s61 offen offset:1024 lds
    buffer_load_dwordx4 v27, s[28:31], s61 offen offset:2048 lds
    buffer_load_dwordx4 v28, s[28:31], s61 offen offset:3072 lds
    s_add_u32 m0, m0, 4096
    s_add_u32 s61, s65, 393472
    buffer_load_dwordx4 v25, s[28:31], s61 offen offset:0 lds
    buffer_load_dwordx4 v26, s[28:31], s61 offen offset:1024 lds
    buffer_load_dwordx4 v27, s[28:31], s61 offen offset:2048 lds
    buffer_load_dwordx4 v28, s[28:31], s61 offen offset:3072 lds
    s_cmp_eq_u32 s3, 0
    s_cselect_b32 s61, 16, 34
    s_lshl_b32 m0, s61, 12
    s_add_u32 s61, s65, 0
    buffer_load_dwordx4 v25, s[28:31], s61 offen offset:0 lds
    buffer_load_dwordx4 v26, s[28:31], s61 offen offset:1024 lds
    buffer_load_dwordx4 v27, s[28:31], s61 offen offset:2048 lds
    buffer_load_dwordx4 v28, s[28:31], s61 offen offset:3072 lds
    s_add_u32 m0, m0, 4096
    s_add_u32 s61, s65, 128
    buffer_load_dwordx4 v25, s[28:31], s61 offen offset:0 lds
    buffer_load_dwordx4 v26, s[28:31], s61 offen offset:1024 lds
    buffer_load_dwordx4 v27, s[28:31], s61 offen offset:2048 lds
    buffer_load_dwordx4 v28, s[28:31], s61 offen offset:3072 lds
    s_add_u32 m0, m0, 4096
    s_add_u32 s61, s65, 256
    buffer_load_dwordx4 v25, s[28:31], s61 offen offset:0 lds
    buffer_load_dwordx4 v26, s[28:31], s61 offen offset:1024 lds
    buffer_load_dwordx4 v27, s[28:31], s61 offen offset:2048 lds
    buffer_load_dwordx4 v28, s[28:31], s61 offen offset:3072 lds
    s_mov_b32 m0, s73
    s_mov_b64 exec, 1
    buffer_load_dword v47, s[24:27], 0 offen offset:40 lds
    s_mov_b64 exec, -1
    s_barrier
    s_add_u32 m0, s66, 90112
    s_add_u32 s61, s44, 0
    buffer_load_dwordx4 v20, s[40:43], s61 offen offset:0 lds
    buffer_load_dwordx4 v21, s[40:43], s61 offen offset:1024 lds
    buffer_load_dwordx4 v22, s[40:43], s61 offen offset:2048 lds
    buffer_load_dwordx4 v23, s[40:43], s61 offen offset:3072 lds
    s_add_u32 m0, s66, 98304
    s_add_u32 s61, s44, 128
    buffer_load_dwordx4 v20, s[40:43], s61 offen offset:0 lds
    buffer_load_dwordx4 v21, s[40:43], s61 offen offset:1024 lds
    buffer_load_dwordx4 v22, s[40:43], s61 offen offset:2048 lds
    buffer_load_dwordx4 v23, s[40:43], s61 offen offset:3072 lds
    s_add_u32 m0, s66, 106496
    s_add_u32 s61, s48, 0
    buffer_load_dwordx4 v20, s[40:43], s61 offen offset:0 lds
    buffer_load_dwordx4 v21, s[40:43], s61 offen offset:1024 lds
    buffer_load_dwordx4 v22, s[40:43], s61 offen offset:2048 lds
    buffer_load_dwordx4 v23, s[40:43], s61 offen offset:3072 lds
    s_add_u32 m0, s66, 8192
    s_add_u32 s61, s50, 0
    buffer_load_dwordx4 v25, s[32:35], s61 offen offset:0 lds
    buffer_load_dwordx4 v26, s[32:35], s61 offen offset:1024 lds
    buffer_load_dwordx4 v27, s[32:35], s61 offen offset:2048 lds
    buffer_load_dwordx4 v28, s[32:35], s61 offen offset:3072 lds
    s_mov_b32 m0, s73
    s_mov_b64 exec, 1
    buffer_load_dword v47, s[24:27], 0 offen offset:48 lds
    s_mov_b64 exec, -1
    s_add_u32 m0, s66, 114688
    s_add_u32 s61, s44, 81920
    buffer_load_dwordx4 v20, s[40:43], s61 offen offset:0 lds
    buffer_load_dwordx4 v21, s[40:43], s61 offen offset:1024 lds
    buffer_load_dwordx4 v22, s[40:43], s61 offen offset:2048 lds
    buffer_load_dwordx4 v23, s[40:43], s61 offen offset:3072 lds
    s_add_u32 m0, s66, 122880
    s_add_u32 s61, s44, 82048
    buffer_load_dwordx4 v20, s[40:43], s61 offen offset:0 lds
    buffer_load_dwordx4 v21, s[40:43], s61 offen offset:1024 lds
    buffer_load_dwordx4 v22, s[40:43], s61 offen offset:2048 lds
    buffer_load_dwordx4 v23, s[40:43], s61 offen offset:3072 lds
    s_barrier
    s_barrier
    s_add_u32 m0, s66, 16384
    s_add_u32 s61, s48, 81920
    buffer_load_dwordx4 v20, s[40:43], s61 offen offset:0 lds
    buffer_load_dwordx4 v21, s[40:43], s61 offen offset:1024 lds
    buffer_load_dwordx4 v22, s[40:43], s61 offen offset:2048 lds
    buffer_load_dwordx4 v23, s[40:43], s61 offen offset:3072 lds
    s_add_u32 m0, s66, 131072
    s_add_u32 s61, s50, 128
    buffer_load_dwordx4 v25, s[32:35], s61 offen offset:0 lds
    buffer_load_dwordx4 v26, s[32:35], s61 offen offset:1024 lds
    buffer_load_dwordx4 v27, s[32:35], s61 offen offset:2048 lds
    buffer_load_dwordx4 v28, s[32:35], s61 offen offset:3072 lds
    s_mov_b32 m0, s73
    s_mov_b64 exec, 1
    buffer_load_dword v47, s[24:27], 0 offen offset:56 lds
    s_mov_b64 exec, -1
    s_add_u32 m0, s66, 24576
    s_add_u32 s61, s44, 163840
    buffer_load_dwordx4 v20, s[40:43], s61 offen offset:0 lds
    buffer_load_dwordx4 v21, s[40:43], s61 offen offset:1024 lds
    buffer_load_dwordx4 v22, s[40:43], s61 offen offset:2048 lds
    buffer_load_dwordx4 v23, s[40:43], s61 offen offset:3072 lds
    s_add_u32 m0, s66, 32768
    s_add_u32 s61, s44, 163968
    buffer_load_dwordx4 v20, s[40:43], s61 offen offset:0 lds
    buffer_load_dwordx4 v21, s[40:43], s61 offen offset:1024 lds
    buffer_load_dwordx4 v22, s[40:43], s61 offen offset:2048 lds
    buffer_load_dwordx4 v23, s[40:43], s61 offen offset:3072 lds
    s_add_u32 m0, s66, 40960
    s_add_u32 s61, s48, 163840
    buffer_load_dwordx4 v20, s[40:43], s61 offen offset:0 lds
    buffer_load_dwordx4 v21, s[40:43], s61 offen offset:1024 lds
    buffer_load_dwordx4 v22, s[40:43], s61 offen offset:2048 lds
    buffer_load_dwordx4 v23, s[40:43], s61 offen offset:3072 lds
    s_add_u32 m0, s66, 49152
    s_add_u32 s61, s50, 256
    buffer_load_dwordx4 v25, s[32:35], s61 offen offset:0 lds
    buffer_load_dwordx4 v26, s[32:35], s61 offen offset:1024 lds
    buffer_load_dwordx4 v27, s[32:35], s61 offen offset:2048 lds
    buffer_load_dwordx4 v28, s[32:35], s61 offen offset:3072 lds
    s_mov_b32 m0, s73
    s_mov_b64 exec, 1
    buffer_load_dword v47, s[24:27], 0 offen offset:64 lds
    s_mov_b64 exec, -1
    s_add_u32 m0, s66, 57344
    s_add_u32 s61, s45, 0
    buffer_load_dwordx4 v20, s[40:43], s61 offen offset:0 lds
    buffer_load_dwordx4 v21, s[40:43], s61 offen offset:1024 lds
    buffer_load_dwordx4 v22, s[40:43], s61 offen offset:2048 lds
    buffer_load_dwordx4 v23, s[40:43], s61 offen offset:3072 lds
    s_add_u32 m0, s66, 65536
    s_add_u32 s61, s45, 128
    buffer_load_dwordx4 v20, s[40:43], s61 offen offset:0 lds
    buffer_load_dwordx4 v21, s[40:43], s61 offen offset:1024 lds
    buffer_load_dwordx4 v22, s[40:43], s61 offen offset:2048 lds
    buffer_load_dwordx4 v23, s[40:43], s61 offen offset:3072 lds
    s_add_u32 m0, s66, 139264
    s_add_u32 s61, s51, 0
    buffer_load_dwordx4 v25, s[32:35], s61 offen offset:0 lds
    buffer_load_dwordx4 v26, s[32:35], s61 offen offset:1024 lds
    buffer_load_dwordx4 v27, s[32:35], s61 offen offset:2048 lds
    buffer_load_dwordx4 v28, s[32:35], s61 offen offset:3072 lds
    s_mov_b32 m0, s73
    s_mov_b64 exec, 1
    buffer_load_dword v47, s[24:27], 0 offen offset:72 lds
    s_mov_b64 exec, -1
    s_add_u32 m0, s66, 73728
    s_add_u32 s61, s45, 81920
    buffer_load_dwordx4 v20, s[40:43], s61 offen offset:0 lds
    buffer_load_dwordx4 v21, s[40:43], s61 offen offset:1024 lds
    buffer_load_dwordx4 v22, s[40:43], s61 offen offset:2048 lds
    buffer_load_dwordx4 v23, s[40:43], s61 offen offset:3072 lds
    s_add_u32 m0, s66, 81920
    s_add_u32 s61, s45, 82048
    buffer_load_dwordx4 v20, s[40:43], s61 offen offset:0 lds
    ds_read_b128 v[40:43], v9 offset:320
    buffer_load_dwordx4 v21, s[40:43], s61 offen offset:1024 lds
    buffer_load_dwordx4 v22, s[40:43], s61 offen offset:2048 lds
    buffer_load_dwordx4 v23, s[40:43], s61 offen offset:3072 lds
L_w_8:
    s_waitcnt lgkmcnt(0)
    v_xor_b32 v40, 255, v40
    v_cmp_ne_u32 vcc, 0, v40
    s_cbranch_vccz L_w_8_ok
    ds_read_b128 v[40:43], v9 offset:320
    s_add_i32 s78, s78, -1
    s_cmp_gt_i32 s78, 0
    s_cbranch_scc1 L_w_8
L_w_8_ok:
    s_add_u32 m0, s66, 8192
    s_add_u32 s61, s51, 128
    buffer_load_dwordx4 v25, s[32:35], s61 offen offset:0 lds
    buffer_load_dwordx4 v26, s[32:35], s61 offen offset:1024 lds
    buffer_load_dwordx4 v27, s[32:35], s61 offen offset:2048 lds
    buffer_load_dwordx4 v28, s[32:35], s61 offen offset:3072 lds
    s_mov_b32 m0, s73
    s_mov_b64 exec, 1
    buffer_load_dword v47, s[24:27], 0 offen offset:80 lds
    s_mov_b64 exec, -1
    s_add_u32 m0, s66, 90112
    s_add_u32 s61, s45, 163840
    buffer_load_dwordx4 v20, s[40:43], s61 offen offset:0 lds
    buffer_load_dwordx4 v21, s[40:43], s61 offen offset:1024 lds
    buffer_load_dwordx4 v22, s[40:43], s61 offen offset:2048 lds
    buffer_load_dwordx4 v23, s[40:43], s61 offen offset:3072 lds
    s_add_u32 m0, s66, 98304
    s_add_u32 s61, s45, 163968
    buffer_load_dwordx4 v20, s[40:43], s61 offen offset:0 lds
    buffer_load_dwordx4 v21, s[40:43], s61 offen offset:1024 lds
    buffer_load_dwordx4 v22, s[40:43], s61 offen offset:2048 lds
    buffer_load_dwordx4 v23, s[40:43], s61 offen offset:3072 lds
    s_add_u32 m0, s66, 106496
    s_add_u32 s61, s51, 256
    buffer_load_dwordx4 v25, s[32:35], s61 offen offset:0 lds
    ds_read_b128 v[40:43], v9 offset:336
    buffer_load_dwordx4 v26, s[32:35], s61 offen offset:1024 lds
    buffer_load_dwordx4 v27, s[32:35], s61 offen offset:2048 lds
    buffer_load_dwordx4 v28, s[32:35], s61 offen offset:3072 lds
    s_mov_b32 m0, s73
    s_mov_b64 exec, 1
    buffer_load_dword v47, s[24:27], 0 offen offset:88 lds
    s_mov_b64 exec, -1
L_w_9:
    s_waitcnt lgkmcnt(0)
    v_xor_b32 v40, 255, v40
    v_cmp_ne_u32 vcc, 0, v40
    s_cbranch_vccz L_w_9_ok
    ds_read_b128 v[40:43], v9 offset:336
    s_add_i32 s78, s78, -1
    s_cmp_gt_i32 s78, 0
    s_cbranch_scc1 L_w_9
L_w_9_ok:
    s_add_u32 m0, s66, 114688
    s_add_u32 s61, s46, 0
    buffer_load_dwordx4 v20, s[40:43], s61 offen offset:0 lds
    buffer_load_dwordx4 v21, s[40:43], s61 offen offset:1024 lds
    buffer_load_dwordx4 v22, s[40:43], s61 offen offset:2048 lds
    buffer_load_dwordx4 v23, s[40:43], s61 offen offset:3072 lds
    s_add_u32 m0, s66, 122880
    s_add_u32 s61, s46, 128
    buffer_load_dwordx4 v20, s[40:43], s61 offen offset:0 lds
    buffer_load_dwordx4 v21, s[40:43], s61 offen offset:1024 lds
    buffer_load_dwordx4 v22, s[40:43], s61 offen offset:2048 lds
    buffer_load_dwordx4 v23, s[40:43], s61 offen offset:3072 lds
    s_add_u32 m0, s66, 16384
    s_add_u32 s61, s49, 0
    buffer_load_dwordx4 v20, s[40:43], s61 offen offset:0 lds
    buffer_load_dwordx4 v21, s[40:43], s61 offen offset:1024 lds
    buffer_load_dwordx4 v22, s[40:43], s61 offen offset:2048 lds
    buffer_load_dwordx4 v23, s[40:43], s61 offen offset:3072 lds
    s_add_u32 m0, s66, 131072
    s_add_u32 s61, s52, 0
    buffer_load_dwordx4 v25, s[32:35], s61 offen offset:0 lds
    ds_read_b128 v[40:43], v9 offset:352
    buffer_load_dwordx4 v26, s[32:35], s61 offen offset:1024 lds
    buffer_load_dwordx4 v27, s[32:35], s61 offen offset:2048 lds
    buffer_load_dwordx4 v28, s[32:35], s61 offen offset:3072 lds
    s_mov_b32 m0, s73
    s_mov_b64 exec, 1
    buffer_load_dword v47, s[24:27], 0 offen offset:96 lds
    s_mov_b64 exec, -1
L_w_10:
    s_waitcnt lgkmcnt(0)
    v_xor_b32 v40, 255, v40
    v_cmp_ne_u32 vcc, 0, v40
    s_cbranch_vccz L_w_10_ok
    ds_read_b128 v[40:43], v9 offset:352
    s_add_i32 s78, s78, -1
    s_cmp_gt_i32 s78, 0
    s_cbranch_scc1 L_w_10
L_w_10_ok:
    s_add_u32 m0, s66, 24576
    s_add_u32 s61, s46, 81920
    buffer_load_dwordx4 v20, s[40:43], s61 offen offset:0 lds
    buffer_load_dwordx4 v21, s[40:43], s61 offen offset:1024 lds
    buffer_load_dwordx4 v22, s[40:43], s61 offen offset:2048 lds
    buffer_load_dwordx4 v23, s[40:43], s61 offen offset:3072 lds
    s_add_u32 m0, s66, 32768
    s_add_u32 s61, s46, 82048
    buffer_load_dwordx4 v20, s[40:43], s61 offen offset:0 lds
    buffer_load_dwordx4 v21, s[40:43], s61 offen offset:1024 lds
    buffer_load_dwordx4 v22, s[40:43], s61 offen offset:2048 lds
    buffer_load_dwordx4 v23, s[40:43], s61 offen offset:3072 lds
    s_add_u32 m0, s66, 40960
    s_add_u32 s61, s49, 81920
    buffer_load_dwordx4 v20, s[40:43], s61 offen offset:0 lds
    buffer_load_dwordx4 v21, s[40:43], s61 offen offset:1024 lds
    buffer_load_dwordx4 v22, s[40:43], s61 offen offset:2048 lds
    buffer_load_dwordx4 v23, s[40:43], s61 offen offset:3072 lds
    s_add_u32 m0, s66, 49152
    s_add_u32 s61, s52, 128
    buffer_load_dwordx4 v25, s[32:35], s61 offen offset:0 lds
    ds_read_b128 v[40:43], v9 offset:368
    buffer_load_dwordx4 v26, s[32:35], s61 offen offset:1024 lds
    buffer_load_dwordx4 v27, s[32:35], s61 offen offset:2048 lds
    buffer_load_dwordx4 v28, s[32:35], s61 offen offset:3072 lds
    s_mov_b32 m0, s73
    s_mov_b64 exec, 1
    buffer_load_dword v47, s[24:27], 0 offen offset:104 lds
    s_mov_b64 exec, -1
L_w_11:
    s_waitcnt lgkmcnt(0)
    v_xor_b32 v40, 255, v40
    v_cmp_ne_u32 vcc, 0, v40
    s_cbranch_vccz L_w_11_ok
    ds_read_b128 v[40:43], v9 offset:368
    s_add_i32 s78, s78, -1
    s_cmp_gt_i32 s78, 0
    s_cbranch_scc1 L_w_11
L_w_11_ok:
    s_add_u32 m0, s66, 57344
    s_add_u32 s61, s46, 163840
    buffer_load_dwordx4 v20, s[40:43], s61 offen offset:0 lds
    buffer_load_dwordx4 v21, s[40:43], s61 offen offset:1024 lds
    buffer_load_dwordx4 v22, s[40:43], s61 offen offset:2048 lds
    buffer_load_dwordx4 v23, s[40:43], s61 offen offset:3072 lds
    s_add_u32 m0, s66, 65536
    s_add_u32 s61, s46, 163968
    buffer_load_dwordx4 v20, s[40:43], s61 offen offset:0 lds
    buffer_load_dwordx4 v21, s[40:43], s61 offen offset:1024 lds
    buffer_load_dwordx4 v22, s[40:43], s61 offen offset:2048 lds
    buffer_load_dwordx4 v23, s[40:43], s61 offen offset:3072 lds
    s_add_u32 m0, s66, 139264
    s_add_u32 s61, s49, 163840
    buffer_load_dwordx4 v20, s[40:43], s61 offen offset:0 lds
    ds_read_b128 v[40:43], v9 offset:384
    buffer_load_dwordx4 v21, s[40:43], s61 offen offset:1024 lds
    buffer_load_dwordx4 v22, s[40:43], s61 offen offset:2048 lds
    buffer_load_dwordx4 v23, s[40:43], s61 offen offset:3072 lds
L_w_12:
    s_waitcnt lgkmcnt(0)
    v_xor_b32 v40, 255, v40
    v_cmp_ne_u32 vcc, 0, v40
    s_cbranch_vccz L_w_12_ok
    ds_read_b128 v[40:43], v9 offset:384
    s_add_i32 s78, s78, -1
    s_cmp_gt_i32 s78, 0
    s_cbranch_scc1 L_w_12
L_w_12_ok:
    s_add_u32 m0, s66, 8192
    s_add_u32 s61, s52, 256
    buffer_load_dwordx4 v25, s[32:35], s61 offen offset:0 lds
    buffer_load_dwordx4 v26, s[32:35], s61 offen offset:1024 lds
    buffer_load_dwordx4 v27, s[32:35], s61 offen offset:2048 lds
    buffer_load_dwordx4 v28, s[32:35], s61 offen offset:3072 lds
    s_mov_b32 m0, s73
    s_mov_b64 exec, 1
    buffer_load_dword v47, s[24:27], 0 offen offset:112 lds
    s_mov_b64 exec, -1
    s_add_u32 m0, s66, 73728
    s_add_u32 s61, s47, 0
    buffer_load_dwordx4 v20, s[40:43], s61 offen offset:0 lds
    buffer_load_dwordx4 v21, s[40:43], s61 offen offset:1024 lds
    buffer_load_dwordx4 v22, s[40:43], s61 offen offset:2048 lds
    buffer_load_dwordx4 v23, s[40:43], s61 offen offset:3072 lds
    s_add_u32 m0, s66, 81920
    s_add_u32 s61, s47, 128
    buffer_load_dwordx4 v20, s[40:43], s61 offen offset:0 lds
    ds_read_b128 v[40:43], v9 offset:400
    buffer_load_dwordx4 v21, s[40:43], s61 offen offset:1024 lds
    buffer_load_dwordx4 v22, s[40:43], s61 offen offset:2048 lds
    buffer_load_dwordx4 v23, s[40:43], s61 offen offset:3072 lds
L_w_13:
    s_waitcnt lgkmcnt(0)
    v_xor_b32 v40, 255, v40
    v_cmp_ne_u32 vcc, 0, v40
    s_cbranch_vccz L_w_13_ok
    ds_read_b128 v[40:43], v9 offset:400
    s_add_i32 s78, s78, -1
    s_cmp_gt_i32 s78, 0
    s_cbranch_scc1 L_w_13
L_w_13_ok:
    s_add_u32 m0, s66, 90112
    s_add_u32 s61, s53, 0
    buffer_load_dwordx4 v25, s[32:35], s61 offen offset:0 lds
    buffer_load_dwordx4 v26, s[32:35], s61 offen offset:1024 lds
    buffer_load_dwordx4 v27, s[32:35], s61 offen offset:2048 lds
    buffer_load_dwordx4 v28, s[32:35], s61 offen offset:3072 lds
    s_mov_b32 m0, s73
    s_mov_b64 exec, 1
    buffer_load_dword v47, s[24:27], 0 offen offset:120 lds
    s_mov_b64 exec, -1
    s_add_u32 m0, s66, 98304
    s_add_u32 s61, s47, 81920
    buffer_load_dwordx4 v20, s[40:43], s61 offen offset:0 lds
    buffer_load_dwordx4 v21, s[40:43], s61 offen offset:1024 lds
    buffer_load_dwordx4 v22, s[40:43], s61 offen offset:2048 lds
    buffer_load_dwordx4 v23, s[40:43], s61 offen offset:3072 lds
    s_add_u32 m0, s66, 106496
    s_add_u32 s61, s47, 82048
    buffer_load_dwordx4 v20, s[40:43], s61 offen offset:0 lds
    ds_read_b128 v[40:43], v9 offset:416
    buffer_load_dwordx4 v21, s[40:43], s61 offen offset:1024 lds
    buffer_load_dwordx4 v22, s[40:43], s61 offen offset:2048 lds
    buffer_load_dwordx4 v23, s[40:43], s61 offen offset:3072 lds
L_w_14:
    s_waitcnt lgkmcnt(0)
    v_xor_b32 v40, 255, v40
    v_cmp_ne_u32 vcc, 0, v40
    s_cbranch_vccz L_w_14_ok
    ds_read_b128 v[40:43], v9 offset:416
    s_add_i32 s78, s78, -1
    s_cmp_gt_i32 s78, 0
    s_cbranch_scc1 L_w_14
L_w_14_ok:
    s_add_u32 m0, s66, 16384
    s_add_u32 s61, s53, 128
    buffer_load_dwordx4 v25, s[32:35], s61 offen offset:0 lds
    buffer_load_dwordx4 v26, s[32:35], s61 offen offset:1024 lds
    buffer_load_dwordx4 v27, s[32:35], s61 offen offset:2048 lds
    buffer_load_dwordx4 v28, s[32:35], s61 offen offset:3072 lds
    s_mov_b32 m0, s73
    s_mov_b64 exec, 1
    buffer_load_dword v47, s[24:27], 0 offen offset:128 lds
    s_mov_b64 exec, -1
    s_add_u32 m0, s66, 114688
    s_add_u32 s61, s47, 163840
    buffer_load_dwordx4 v20, s[40:43], s61 offen offset:0 lds
    buffer_load_dwordx4 v21, s[40:43], s61 offen offset:1024 lds
    buffer_load_dwordx4 v22, s[40:43], s61 offen offset:2048 lds
    buffer_load_dwordx4 v23, s[40:43], s61 offen offset:3072 lds
    s_add_u32 m0, s66, 122880
    s_add_u32 s61, s47, 163968
    buffer_load_dwordx4 v20, s[40:43], s61 offen offset:0 lds
    buffer_load_dwordx4 v21, s[40:43], s61 offen offset:1024 lds
    buffer_load_dwordx4 v22, s[40:43], s61 offen offset:2048 lds
    buffer_load_dwordx4 v23, s[40:43], s61 offen offset:3072 lds
    s_add_u32 m0, s66, 131072
    s_add_u32 s61, s53, 256
    buffer_load_dwordx4 v25, s[32:35], s61 offen offset:0 lds
    buffer_load_dwordx4 v26, s[32:35], s61 offen offset:1024 lds
    buffer_load_dwordx4 v27, s[32:35], s61 offen offset:2048 lds
    buffer_load_dwordx4 v28, s[32:35], s61 offen offset:3072 lds
    s_mov_b32 m0, s73
    s_mov_b64 exec, 1
    buffer_load_dword v47, s[24:27], 0 offen offset:136 lds
    s_mov_b64 exec, -1
L_ldend:
    s_setprio 0
    s_mov_b32 s54, 33554432
    s_mov_b32 s55, 0x20000
    s_mov_b64 s[52:53], s[18:19]
    v_lshlrev_b32 v34, 4, v0
    s_lshl_b32 s61, s3, 10
    s_and_b32 s62, s2, 0xf8
    s_and_b32 s49, s22, 1
    s_mul_i32 s49, s49, 384
    s_lshl_b32 s63, s3, 7
    s_add_u32 s49, s49, s63
    v_lshrrev_b32 v3, 3, v0
L_reduce:
    s_mov_b32 s46, 655360
    s_mov_b32 s47, 0x20000
    s_mov_b64 s[44:45], s[14:15]
    v_and_b32 v2, 7, v0
    v_mul_u32_u24 v2, 1280, v2
    v_lshl_add_u32 v35, v3, 4, v2
    s_mul_i32 s62, s62, 24576
    s_mul_i32 s63, s23, 3072
    s_add_u32 s62, s62, s63
    s_add_u32 s62, s62, s61
    s_add_u32 s56, s62, 16777216
    s_lshl_b32 s62, s21, 3
    s_add_u32 s62, s62, s23
    s_mul_i32 s62, s62, 8*1280
    s_lshr_b32 s63, s22, 1
    s_mul_i32 s63, s63, 640
    s_add_u32 s62, s62, s63
    s_add_u32 s48, s62, s49
    s_add_u32 s57, s56, 24576
    s_add_u32 s58, s56, 49152
    s_add_u32 s59, s56, 73728
    s_add_u32 s60, s56, 98304
    s_add_u32 s61, s56, 122880
    s_add_u32 s62, s56, 147456
    s_add_u32 s63, s56, 172032
    s_mov_b64 s[4:5], -1
    s_mov_b64 s[6:7], -1
    s_mov_b64 s[8:9], -1
    s_mov_b64 s[10:11], -1
    s_mov_b64 s[12:13], -1
    s_mov_b64 s[14:15], -1
    s_mov_b64 s[16:17], -1
    s_mov_b64 s[20:21], -1
    v_mov_b32 v112, 0
    v_mov_b32 v113, 0
    v_mov_b32 v114, 0
    v_mov_b32 v115, 0
    v_mov_b32 v116, 0
    v_mov_b32 v117, 0
    v_mov_b32 v118, 0
    v_mov_b32 v119, 0
    s_movk_i32 s75, 255
    s_cmp_lg_u32 s3, 2
    s_cbranch_scc1 L_g
    ds_read_b64 v[40:41], v9 offset:136
L_w_15:
    s_waitcnt lgkmcnt(0)
    v_or_b32 v40, v40, v41
    v_cmp_ne_u32 vcc, 0, v40
    s_cbranch_vccz L_w_15_ok
    ds_read_b64 v[40:41], v9 offset:136
    s_add_i32 s78, s78, -1
    s_cmp_gt_i32 s78, 0
    s_cbranch_scc1 L_w_15
L_w_15_ok:
L_c2h:
    buffer_load_dwordx2 v[24:25], v11, s[52:55], s64 offen sc1
    s_waitcnt vmcnt(0)
    v_cmp_ne_u64 vcc, s[72:73], v[24:25]
    s_cbranch_vccz L_c2h_ok
    s_add_i32 s78, s78, -1
    s_cmp_gt_i32 s78, 0
    s_cbranch_scc1 L_c2h
L_c2h_ok:
    ds_write_b32 v9, v9 offset:272
L_g:
    ds_read_b128 v[40:43], v9 offset:512
    ds_read_b32 v44, v9 offset:272
    s_waitcnt lgkmcnt(0)
    v_or3_b32 v40, v40, v41, v42
    v_or3_b32 v40, v40, v43, v44
    v_cmp_ne_u32 vcc, 0, v40
    s_cbranch_vccz L_g_ok
    s_add_i32 s78, s78, -1
    s_cmp_gt_i32 s78, 0
    s_cbranch_scc1 L_g
L_g_ok:
    buffer_load_dwordx4 v[48:51], v34, s[52:55], s56 offen sc1
    buffer_load_dwordx4 v[52:55], v34, s[52:55], s57 offen sc1
    buffer_load_dwordx4 v[56:59], v34, s[52:55], s58 offen sc1
    buffer_load_dwordx4 v[60:63], v34, s[52:55], s59 offen sc1
    buffer_load_dwordx4 v[64:67], v34, s[52:55], s60 offen sc1
    buffer_load_dwordx4 v[68:71], v34, s[52:55], s61 offen sc1
    buffer_load_dwordx4 v[72:75], v34, s[52:55], s62 offen sc1
    buffer_load_dwordx4 v[76:79], v34, s[52:55], s63 offen sc1
    s_setprio 3
L_radd2:
    s_mov_b64 s[74:75], 0
    s_cmp_eq_u64 s[4:5], 0
    s_cbranch_scc1 L_ra0
    s_waitcnt vmcnt(7)
    v_max3_u32 v1, v48, v49, v50
    v_max_u32 v1, v1, v51
    v_cmp_eq_u32 vcc, -1, v1
    v_lshlrev_b32 v120, 16, v48
    v_and_b32 v121, 0xffff0000, v48
    v_lshlrev_b32 v122, 16, v49
    v_and_b32 v123, 0xffff0000, v49
    v_lshlrev_b32 v124, 16, v50
    v_and_b32 v125, 0xffff0000, v50
    v_lshlrev_b32 v126, 16, v51
    v_and_b32 v127, 0xffff0000, v51
    s_mov_b64 s[4:5], vcc
    s_or_b64 s[74:75], s[74:75], vcc
    s_cbranch_vccnz L_ra0
    v_pk_add_f32 v[112:113], v[112:113], v[120:121]
    v_pk_add_f32 v[114:115], v[114:115], v[122:123]
    v_pk_add_f32 v[116:117], v[116:117], v[124:125]
    v_pk_add_f32 v[118:119], v[118:119], v[126:127]
L_ra0:
    s_cmp_eq_u64 s[6:7], 0
    s_cbranch_scc1 L_ra1
    s_waitcnt vmcnt(6)
    v_max3_u32 v1, v52, v53, v54
    v_max_u32 v1, v1, v55
    v_cmp_eq_u32 vcc, -1, v1
    v_lshlrev_b32 v120, 16, v52
    v_and_b32 v121, 0xffff0000, v52
    v_lshlrev_b32 v122, 16, v53
    v_and_b32 v123, 0xffff0000, v53
    v_lshlrev_b32 v124, 16, v54
    v_and_b32 v125, 0xffff0000, v54
    v_lshlrev_b32 v126, 16, v55
    v_and_b32 v127, 0xffff0000, v55
    s_mov_b64 s[6:7], vcc
    s_or_b64 s[74:75], s[74:75], vcc
    s_cbranch_vccnz L_ra1
    v_pk_add_f32 v[112:113], v[112:113], v[120:121]
    v_pk_add_f32 v[114:115], v[114:115], v[122:123]
    v_pk_add_f32 v[116:117], v[116:117], v[124:125]
    v_pk_add_f32 v[118:119], v[118:119], v[126:127]
L_ra1:
    s_cmp_eq_u64 s[8:9], 0
    s_cbranch_scc1 L_ra2
    s_waitcnt vmcnt(5)
    v_max3_u32 v1, v56, v57, v58
    v_max_u32 v1, v1, v59
    v_cmp_eq_u32 vcc, -1, v1
    v_lshlrev_b32 v120, 16, v56
    v_and_b32 v121, 0xffff0000, v56
    v_lshlrev_b32 v122, 16, v57
    v_and_b32 v123, 0xffff0000, v57
    v_lshlrev_b32 v124, 16, v58
    v_and_b32 v125, 0xffff0000, v58
    v_lshlrev_b32 v126, 16, v59
    v_and_b32 v127, 0xffff0000, v59
    s_mov_b64 s[8:9], vcc
    s_or_b64 s[74:75], s[74:75], vcc
    s_cbranch_vccnz L_ra2
    v_pk_add_f32 v[112:113], v[112:113], v[120:121]
    v_pk_add_f32 v[114:115], v[114:115], v[122:123]
    v_pk_add_f32 v[116:117], v[116:117], v[124:125]
    v_pk_add_f32 v[118:119], v[118:119], v[126:127]
L_ra2:
    s_cmp_eq_u64 s[10:11], 0
    s_cbranch_scc1 L_ra3
    s_waitcnt vmcnt(4)
    v_max3_u32 v1, v60, v61, v62
    v_max_u32 v1, v1, v63
    v_cmp_eq_u32 vcc, -1, v1
    v_lshlrev_b32 v120, 16, v60
    v_and_b32 v121, 0xffff0000, v60
    v_lshlrev_b32 v122, 16, v61
    v_and_b32 v123, 0xffff0000, v61
    v_lshlrev_b32 v124, 16, v62
    v_and_b32 v125, 0xffff0000, v62
    v_lshlrev_b32 v126, 16, v63
    v_and_b32 v127, 0xffff0000, v63
    s_mov_b64 s[10:11], vcc
    s_or_b64 s[74:75], s[74:75], vcc
    s_cbranch_vccnz L_ra3
    v_pk_add_f32 v[112:113], v[112:113], v[120:121]
    v_pk_add_f32 v[114:115], v[114:115], v[122:123]
    v_pk_add_f32 v[116:117], v[116:117], v[124:125]
    v_pk_add_f32 v[118:119], v[118:119], v[126:127]
L_ra3:
    s_cmp_eq_u64 s[12:13], 0
    s_cbranch_scc1 L_ra4
    s_waitcnt vmcnt(3)
    v_max3_u32 v1, v64, v65, v66
    v_max_u32 v1, v1, v67
    v_cmp_eq_u32 vcc, -1, v1
    v_lshlrev_b32 v120, 16, v64
    v_and_b32 v121, 0xffff0000, v64
    v_lshlrev_b32 v122, 16, v65
    v_and_b32 v123, 0xffff0000, v65
    v_lshlrev_b32 v124, 16, v66
    v_and_b32 v125, 0xffff0000, v66
    v_lshlrev_b32 v126, 16, v67
    v_and_b32 v127, 0xffff0000, v67
    s_mov_b64 s[12:13], vcc
    s_or_b64 s[74:75], s[74:75], vcc
    s_cbranch_vccnz L_ra4
    v_pk_add_f32 v[112:113], v[112:113], v[120:121]
    v_pk_add_f32 v[114:115], v[114:115], v[122:123]
    v_pk_add_f32 v[116:117], v[116:117], v[124:125]
    v_pk_add_f32 v[118:119], v[118:119], v[126:127]
L_ra4:
    s_cmp_eq_u64 s[14:15], 0
    s_cbranch_scc1 L_ra5
    s_waitcnt vmcnt(2)
    v_max3_u32 v1, v68, v69, v70
    v_max_u32 v1, v1, v71
    v_cmp_eq_u32 vcc, -1, v1
    v_lshlrev_b32 v120, 16, v68
    v_and_b32 v121, 0xffff0000, v68
    v_lshlrev_b32 v122, 16, v69
    v_and_b32 v123, 0xffff0000, v69
    v_lshlrev_b32 v124, 16, v70
    v_and_b32 v125, 0xffff0000, v70
    v_lshlrev_b32 v126, 16, v71
    v_and_b32 v127, 0xffff0000, v71
    s_mov_b64 s[14:15], vcc
    s_or_b64 s[74:75], s[74:75], vcc
    s_cbranch_vccnz L_ra5
    v_pk_add_f32 v[112:113], v[112:113], v[120:121]
    v_pk_add_f32 v[114:115], v[114:115], v[122:123]
    v_pk_add_f32 v[116:117], v[116:117], v[124:125]
    v_pk_add_f32 v[118:119], v[118:119], v[126:127]
L_ra5:
    s_cmp_eq_u64 s[16:17], 0
    s_cbranch_scc1 L_ra6
    s_waitcnt vmcnt(1)
    v_max3_u32 v1, v72, v73, v74
    v_max_u32 v1, v1, v75
    v_cmp_eq_u32 vcc, -1, v1
    v_lshlrev_b32 v120, 16, v72
    v_and_b32 v121, 0xffff0000, v72
    v_lshlrev_b32 v122, 16, v73
    v_and_b32 v123, 0xffff0000, v73
    v_lshlrev_b32 v124, 16, v74
    v_and_b32 v125, 0xffff0000, v74
    v_lshlrev_b32 v126, 16, v75
    v_and_b32 v127, 0xffff0000, v75
    s_mov_b64 s[16:17], vcc
    s_or_b64 s[74:75], s[74:75], vcc
    s_cbranch_vccnz L_ra6
    v_pk_add_f32 v[112:113], v[112:113], v[120:121]
    v_pk_add_f32 v[114:115], v[114:115], v[122:123]
    v_pk_add_f32 v[116:117], v[116:117], v[124:125]
    v_pk_add_f32 v[118:119], v[118:119], v[126:127]
L_ra6:
    s_cmp_eq_u64 s[20:21], 0
    s_cbranch_scc1 L_ra7
    s_waitcnt vmcnt(0)
    v_max3_u32 v1, v76, v77, v78
    v_max_u32 v1, v1, v79
    v_cmp_eq_u32 vcc, -1, v1
    v_lshlrev_b32 v120, 16, v76
    v_and_b32 v121, 0xffff0000, v76
    v_lshlrev_b32 v122, 16, v77
    v_and_b32 v123, 0xffff0000, v77
    v_lshlrev_b32 v124, 16, v78
    v_and_b32 v125, 0xffff0000, v78
    v_lshlrev_b32 v126, 16, v79
    v_and_b32 v127, 0xffff0000, v79
    s_mov_b64 s[20:21], vcc
    s_or_b64 s[74:75], s[74:75], vcc
    s_cbranch_vccnz L_ra7
    v_pk_add_f32 v[112:113], v[112:113], v[120:121]
    v_pk_add_f32 v[114:115], v[114:115], v[122:123]
    v_pk_add_f32 v[116:117], v[116:117], v[124:125]
    v_pk_add_f32 v[118:119], v[118:119], v[126:127]
L_ra7:
    s_cmp_eq_u64 s[74:75], 0
    s_cbranch_scc1 L_round_ok
    s_mov_b64 exec, s[4:5]
    s_cbranch_execz L_rb0
    buffer_load_dwordx4 v[48:51], v34, s[52:55], s56 offen sc1
L_rb0:
    s_mov_b64 exec, s[6:7]
    s_cbranch_execz L_rb1
    buffer_load_dwordx4 v[52:55], v34, s[52:55], s57 offen sc1
L_rb1:
    s_mov_b64 exec, s[8:9]
    s_cbranch_execz L_rb2
    buffer_load_dwordx4 v[56:59], v34, s[52:55], s58 offen sc1
L_rb2:
    s_mov_b64 exec, s[10:11]
    s_cbranch_execz L_rb3
    buffer_load_dwordx4 v[60:63], v34, s[52:55], s59 offen sc1
L_rb3:
    s_mov_b64 exec, s[12:13]
    s_cbranch_execz L_rb4
    buffer_load_dwordx4 v[64:67], v34, s[52:55], s60 offen sc1
L_rb4:
    s_mov_b64 exec, s[14:15]
    s_cbranch_execz L_rb5
    buffer_load_dwordx4 v[68:71], v34, s[52:55], s61 offen sc1
L_rb5:
    s_mov_b64 exec, s[16:17]
    s_cbranch_execz L_rb6
    buffer_load_dwordx4 v[72:75], v34, s[52:55], s62 offen sc1
L_rb6:
    s_mov_b64 exec, s[20:21]
    s_cbranch_execz L_rb7
    buffer_load_dwordx4 v[76:79], v34, s[52:55], s63 offen sc1
L_rb7:
    s_mov_b64 exec, -1
    s_waitcnt vmcnt(0)
    s_add_i32 s78, s78, -1
    s_cmp_gt_i32 s78, 0
    s_cbranch_scc1 L_radd2
L_round_ok:
    s_mov_b64 exec, -1
    s_cmp_lg_u32 s3, 2
    s_cbranch_scc1 L_rfin
    v_mov_b32 v120, v112
    v_mov_b32 v121, v113
    v_mov_b32 v122, v114
    v_mov_b32 v123, v115
    v_mov_b32 v124, v116
    v_mov_b32 v125, v117
    v_mov_b32 v126, v118
    v_mov_b32 v127, v119
    v_permlane32_swap_b32 v112, v120
    v_permlane32_swap_b32 v113, v121
    v_permlane32_swap_b32 v114, v122
    v_permlane32_swap_b32 v115, v123
    v_permlane32_swap_b32 v116, v124
    v_permlane32_swap_b32 v117, v125
    v_permlane32_swap_b32 v118, v126
    v_permlane32_swap_b32 v119, v127
    v_add_f32 v112, v112, v120
    v_add_f32 v113, v113, v121
    v_add_f32 v114, v114, v122
    v_add_f32 v115, v115, v123
    v_add_f32 v116, v116, v124
    v_add_f32 v117, v117, v125
    v_add_f32 v118, v118, v126
    v_add_f32 v119, v119, v127
    s_mov_b32 exec_hi, 0
L_rfin:
    v_cvt_pk_bf16_f32 v120, v112, v113
    v_cvt_pk_bf16_f32 v121, v114, v115
    v_cvt_pk_bf16_f32 v122, v116, v117
    v_cvt_pk_bf16_f32 v123, v118, v119
    buffer_store_dwordx4 v[120:123], v35, s[44:47], s48 offen
    s_endpgm
    .p2align 6
L_notload:
    s_cmp_ge_u32 s3, 4
    s_cbranch_scc1 L_compute
    s_memrealtime s[72:73]
    s_and_b32 s79, s3, 1
    s_mov_b32 s50, 256
    s_mov_b32 s51, 0x20000
    s_mov_b32 s54, 33554432
    s_mov_b32 s55, 0x20000
    s_setprio 3
    v_mov_b32 v9, 0
    s_lshl_b32 s61, s79, 2
    v_mov_b32 v8, s61
    v_lshlrev_b32 v10, 4, v0
    v_lshlrev_b32 v11, 3, v0
    v_mov_b32 v12, -1
    v_mov_b32 v13, -1
    v_mov_b32 v14, -1
    v_mov_b32 v15, -1
    ds_write_b64 v11, v[12:13] offset:256
    s_lshl_b32 s60, s2, 1
    s_add_u32 s60, s60, s79
    s_mul_i32 s56, s60, 12288
    s_add_u32 s56, s56, 16777216
    s_lshl_b32 s57, s60, 11
    s_lshl_b32 s58, s60, 12
    s_add_u32 s58, s58, 2097152
    s_lshl_b32 s59, s60, 7
    s_add_u32 s59, s59, 9437184
    s_cmp_eq_u32 s79, 0
    s_cselect_b32 s61, s22, s70
    s_add_i32 s61, s61, -1
    s_cmp_lt_i32 s61, 0
    s_cselect_b32 s61, 4, s61
    s_cmp_eq_u32 s79, 0
    s_cbranch_scc0 L_pfx
    s_mul_i32 s62, s71, 5
    s_add_u32 s61, s61, s62
    s_lshl_b32 s61, s61, 2
    s_add_u32 s61, s61, s70
    s_mul_i32 s61, s61, 16*12288
    s_mul_i32 s62, s20, 384
    s_add_u32 s61, s61, s62
    v_and_b32 v1, 15, v0
    v_mul_u32_u24 v1, 12288, v1
    v_lshrrev_b32 v2, 4, v0
    v_lshl_add_u32 v1, v2, 7, v1
    s_waitcnt lgkmcnt(0)
    s_mov_b64 s[62:63], s[10:11]
    s_mov_b32 exec_hi, 0xffff
    s_branch L_pfj
L_pfx:
    s_lshl_b32 s61, s61, 7
    s_lshl_b32 s62, s70, 2
    s_add_u32 s62, s62, s22
    s_lshl_b32 s62, s62, 6
    s_add_u32 s62, s62, s71
    s_mul_i32 s62, s62, 640
    s_add_u32 s61, s61, s62
    v_mul_u32_u24 v1, 1280, v0
    s_waitcnt lgkmcnt(0)
    s_mov_b64 s[62:63], s[4:5]
    s_mov_b32 exec_hi, 0
L_pfj:
    s_add_u32 s62, s62, s61
    s_addc_u32 s63, s63, 0
    s_mov_b64 exec, 1
    global_load_dword v22, v1, s[62:63]
    s_mov_b64 exec, -1
    s_mov_b64 s[48:49], s[16:17]
    s_mov_b64 s[52:53], s[18:19]
    s_or_b32 s74, s2, s79
    s_cmp_lg_u32 s74, 0
    s_cbranch_scc1 L_notleader
    s_lshl_b64 s[72:73], s[72:73], 5
    s_or_b32 s72, s72, 1
    v_mov_b32 v18, s72
    v_mov_b32 v19, s73
    s_mov_b64 exec, 1
    buffer_store_dwordx2 v[18:19], v9, s[48:51], 0 offen sc1
    s_mov_b64 exec, -1
L_notleader:
    s_barrier
    v_bfe_u32 v1, v0, 1, 4
    s_and_b32 s61, s2, 0xf0
    v_add_u32 v1, s61, v1
    v_and_b32 v2, 1, v0
    v_lshlrev_b32 v3, 3, v2
    v_lshl_add_u32 v11, v1, 7, v3
    v_bfe_u32 v1, v0, 1, 3
    s_and_b32 s61, s2, 0xc7
    v_lshl_add_u32 v1, v1, 3, s61
    v_lshl_add_u32 v1, v1, 1, v2
    v_lshlrev_b32 v17, 7, v1
    s_xor_b32 s58, s58, 262144
    s_add_u32 s62, s22, s70
    s_mov_b32 s57, s58
    s_andn2_b32 s63, s57, 0x30000
    s_add_u32 s61, s62, 0
    s_and_b32 s61, s61, 3
    s_lshl_b32 s61, s61, 16
    s_add_u32 s64, s63, s61
    s_add_u32 s61, s62, 1
    s_and_b32 s61, s61, 3
    s_lshl_b32 s61, s61, 16
    s_add_u32 s65, s63, s61
    s_add_u32 s61, s62, 2
    s_and_b32 s61, s61, 3
    s_lshl_b32 s61, s61, 16
    s_add_u32 s66, s63, s61
    s_add_u32 s61, s62, 3
    s_and_b32 s61, s61, 3
    s_lshl_b32 s61, s61, 16
    s_add_u32 s67, s63, s61
    s_lshl_b32 s61, s79, 13
    s_add_u32 s61, s61, 147456
    v_add_u32 v16, s61, v10
    s_mov_b32 s74, 0x3dd53b95
    s_mov_b32 s62, 9437184
    s_mov_b32 s63, 10485760
    s_lshl_b32 s60, s2, 7
    s_lshl_b32 s61, s79, 3
    s_add_u32 s60, s60, s61
    s_add_u32 s60, s60, s63
    s_waitcnt vmcnt(0)
    buffer_load_dwordx2 v[18:19], v9, s[48:51], 0 offen sc1
    s_barrier
    s_barrier
    s_waitcnt vmcnt(0)
L_nonce:
    v_readfirstlane_b32 s72, v18
    v_readfirstlane_b32 s73, v19
    s_cmp_lg_u32 s72, 0
    s_cbranch_scc1 L_nonce_ok
    buffer_load_dwordx2 v[18:19], v9, s[48:51], 0 offen sc1
    s_waitcnt vmcnt(0)
    s_add_i32 s78, s78, -1
    s_cmp_gt_i32 s78, 0
    s_cbranch_scc1 L_nonce
L_nonce_ok:
    s_getreg_b32 s76, hwreg(HW_REG_XCC_ID, 0, 4)
    s_lshl_b32 s76, s76, 1
    s_or_b32 s76, s76, s72
    v_mov_b32 v36, s76
    v_mov_b32 v37, v19
    v_mov_b32 v38, s76
    v_mov_b32 v39, v19
    s_mov_b64 exec, 0xff
    buffer_store_dwordx4 v[36:39], v10, s[52:55], s59 offen sc1
    s_mov_b64 exec, -1
    s_mov_b32 s61, 0x9e3779b1
    v_mul_lo_u32 v1, v0, s61
    v_add_u32 v2, v18, v1
    v_xor_b32 v3, v19, v1
    s_mov_b32 s61, 0x85ebca6b
    v_mul_lo_u32 v2, v2, s61
    s_mov_b32 s61, 0xc2b2ae35
    v_mul_lo_u32 v3, v3, s61
    v_alignbit_b32 v2, v2, v2, 13
    v_xor_b32 v2, v2, v3
    v_mul_lo_u32 v2, v2, s61
    v_lshrrev_b32 v3, 16, v2
    v_xor_b32 v44, v2, v3
    v_alignbit_b32 v45, v44, v44, 8
    v_alignbit_b32 v46, v44, v44, 18
    v_alignbit_b32 v47, v44, v44, 26
    ds_write_b128 v10, v[44:47] offset:1024
    s_mov_b32 s69, 0xc000c000
    s_waitcnt lgkmcnt(0)
    s_barrier
    s_barrier
    s_barrier
    buffer_load_dwordx2 v[24:25], v17, s[52:55], s62 offen sc1
    s_barrier
    s_waitcnt vmcnt(0)
L_c2:
    v_and_b32 v2, 0xffffffe1, v24
    v_mov_b32 v3, v25
    v_cmp_ne_u64 vcc, s[72:73], v[2:3]
    s_cbranch_vccz L_c2_ok
    buffer_load_dwordx2 v[24:25], v17, s[52:55], s62 offen sc1
    s_waitcnt vmcnt(0)
    s_add_i32 s78, s78, -1
    s_cmp_gt_i32 s78, 0
    s_cbranch_scc1 L_c2
L_c2_ok:
    v_cmp_ne_u32 vcc, s76, v24
    s_cmp_lg_u64 vcc, 0
    s_cselect_b32 s77, 1, 0
    s_cbranch_scc1 L_slowS
    ds_read_b32 v40, v8 offset:256
L_w_16:
    s_waitcnt lgkmcnt(0)
    v_cmp_ne_u32 vcc, 0, v40
    s_cbranch_vccz L_w_16_ok
    ds_read_b32 v40, v8 offset:256
    s_add_i32 s78, s78, -1
    s_cmp_gt_i32 s78, 0
    s_cbranch_scc1 L_w_16
L_w_16_ok:
L_sp:
    buffer_load_dwordx4 v[64:67], v10, s[52:55], s58 offen offset:0 sc1
    buffer_load_dwordx4 v[68:71], v10, s[52:55], s58 offen offset:1024 sc1
    buffer_load_dwordx4 v[72:75], v10, s[52:55], s58 offen offset:2048 sc1
    buffer_load_dwordx4 v[76:79], v10, s[52:55], s58 offen offset:3072 sc1
    s_waitcnt vmcnt(3)
    v_xor_b32 v1, v64, v44
    v_bitop3_b32 v1, v1, v65, v45 bitop3:0xf6
    v_bitop3_b32 v1, v1, v66, v46 bitop3:0xf6
    v_bitop3_b32 v1, v1, v67, v47 bitop3:0xf6
    s_waitcnt vmcnt(2)
    v_bitop3_b32 v1, v1, v68, v44 bitop3:0xf6
    v_bitop3_b32 v1, v1, v69, v45 bitop3:0xf6
    v_bitop3_b32 v1, v1, v70, v46 bitop3:0xf6
    v_bitop3_b32 v1, v1, v71, v47 bitop3:0xf6
    s_waitcnt vmcnt(1)
    v_bitop3_b32 v1, v1, v72, v44 bitop3:0xf6
    v_bitop3_b32 v1, v1, v73, v45 bitop3:0xf6
    v_bitop3_b32 v1, v1, v74, v46 bitop3:0xf6
    v_bitop3_b32 v1, v1, v75, v47 bitop3:0xf6
    s_waitcnt vmcnt(0)
    v_bitop3_b32 v1, v1, v76, v44 bitop3:0xf6
    v_bitop3_b32 v1, v1, v77, v45 bitop3:0xf6
    v_bitop3_b32 v1, v1, v78, v46 bitop3:0xf6
    v_bitop3_b32 v1, v1, v79, v47 bitop3:0xf6
    v_and_b32 v1, 255, v1
    v_cmp_ne_u32 vcc, 0, v1
    s_cbranch_vccz L_sp_ok
    s_add_i32 s78, s78, -1
    s_cmp_gt_i32 s78, 0
    s_cbranch_scc1 L_sp
L_sp_ok:
L_haveS:
    ds_read_b32 v40, v8 offset:256
L_w_17:
    s_waitcnt lgkmcnt(0)
    v_cmp_ne_u32 vcc, 0, v40
    s_cbranch_vccz L_w_17_ok
    ds_read_b32 v40, v8 offset:256
    s_add_i32 s78, s78, -1
    s_cmp_gt_i32 s78, 0
    s_cbranch_scc1 L_w_17
L_w_17_ok:
    ds_read_b128 v[48:51], v16 offset:0
    ds_read_b128 v[52:55], v16 offset:1024
    ds_read_b128 v[56:59], v16 offset:2048
    ds_read_b128 v[60:63], v16 offset:3072
    v_and_b32 v64, 0xffffff00, v64
    v_and_b32 v65, 0xffffff00, v65
    v_and_b32 v66, 0xffffff00, v66
    v_and_b32 v67, 0xffffff00, v67
    v_and_b32 v68, 0xffffff00, v68
    v_and_b32 v69, 0xffffff00, v69
    v_and_b32 v70, 0xffffff00, v70
    v_and_b32 v71, 0xffffff00, v71
    v_and_b32 v72, 0xffffff00, v72
    v_and_b32 v73, 0xffffff00, v73
    v_and_b32 v74, 0xffffff00, v74
    v_and_b32 v75, 0xffffff00, v75
    v_and_b32 v76, 0xffffff00, v76
    v_and_b32 v77, 0xffffff00, v77
    v_and_b32 v78, 0xffffff00, v78
    v_and_b32 v79, 0xffffff00, v79
    s_waitcnt lgkmcnt(3)
    v_add_f32 v48, v48, v64
    v_add_f32 v49, v49, v65
    v_add_f32 v50, v50, v66
    v_add_f32 v51, v51, v67
    s_waitcnt lgkmcnt(2)
    v_add_f32 v52, v52, v68
    v_add_f32 v53, v53, v69
    v_add_f32 v54, v54, v70
    v_add_f32 v55, v55, v71
    s_waitcnt lgkmcnt(1)
    v_add_f32 v56, v56, v72
    v_add_f32 v57, v57, v73
    v_add_f32 v58, v58, v74
    v_add_f32 v59, v59, v75
    s_waitcnt lgkmcnt(0)
    v_add_f32 v60, v60, v76
    v_add_f32 v61, v61, v77
    v_add_f32 v62, v62, v78
    v_add_f32 v63, v63, v79
    v_max3_f32 v1, v48, v49, v50
    v_max3_f32 v2, v51, v52, v53
    v_max3_f32 v3, v54, v55, v56
    v_max3_f32 v4, v57, v58, v59
    v_max3_f32 v5, v60, v61, v62
    v_max3_f32 v1, v1, v2, v3
    v_max3_f32 v4, v4, v5, v63
    v_max_f32 v2, v1, v4
    v_max_f32 v3, v1, v4
    s_nop 1
    v_permlane32_swap_b32 v2, v3
    s_nop 0
    v_max_f32 v2, v2, v3
    v_mul_f32 v2, 0xbdd53b95, v2
    v_fma_f32 v48, v48, s74, v2
    v_fma_f32 v49, v49, s74, v2
    v_fma_f32 v50, v50, s74, v2
    v_fma_f32 v51, v51, s74, v2
    v_fma_f32 v52, v52, s74, v2
    v_fma_f32 v53, v53, s74, v2
    v_fma_f32 v54, v54, s74, v2
    v_fma_f32 v55, v55, s74, v2
    v_fma_f32 v56, v56, s74, v2
    v_fma_f32 v57, v57, s74, v2
    v_fma_f32 v58, v58, s74, v2
    v_fma_f32 v59, v59, s74, v2
    v_fma_f32 v60, v60, s74, v2
    v_fma_f32 v61, v61, s74, v2
    v_fma_f32 v62, v62, s74, v2
    v_fma_f32 v63, v63, s74, v2
    v_exp_f32 v48, v48
    v_exp_f32 v49, v49
    v_exp_f32 v50, v50
    v_exp_f32 v51, v51
    v_exp_f32 v52, v52
    v_exp_f32 v53, v53
    v_exp_f32 v54, v54
    v_exp_f32 v55, v55
    v_exp_f32 v56, v56
    v_exp_f32 v57, v57
    v_exp_f32 v58, v58
    v_exp_f32 v59, v59
    v_exp_f32 v60, v60
    v_exp_f32 v61, v61
    v_exp_f32 v62, v62
    v_exp_f32 v63, v63
    v_add_f32 v64, v48, v56
    v_add_f32 v65, v49, v57
    v_add_f32 v66, v50, v58
    v_add_f32 v67, v51, v59
    v_add_f32 v68, v52, v60
    v_add_f32 v69, v53, v61
    v_add_f32 v70, v54, v62
    v_add_f32 v71, v55, v63
    v_add_f32 v64, v64, v68
    v_add_f32 v65, v65, v69
    v_add_f32 v66, v66, v70
    v_add_f32 v67, v67, v71
    v_add_f32 v64, v64, v66
    v_add_f32 v65, v65, v67
    v_add_f32 v2, v64, v65
    v_add_f32 v3, v64, v65
    s_nop 1
    v_permlane32_swap_b32 v2, v3
    s_nop 0
    v_add_f32 v2, v2, v3
    v_rcp_f32 v2, v2
    s_nop 0
    v_mul_f32 v48, v48, v2
    v_mul_f32 v49, v49, v2
    v_mul_f32 v50, v50, v2
    v_mul_f32 v51, v51, v2
    v_mul_f32 v52, v52, v2
    v_mul_f32 v53, v53, v2
    v_mul_f32 v54, v54, v2
    v_mul_f32 v55, v55, v2
    v_mul_f32 v56, v56, v2
    v_mul_f32 v57, v57, v2
    v_mul_f32 v58, v58, v2
    v_mul_f32 v59, v59, v2
    v_mul_f32 v60, v60, v2
    v_mul_f32 v61, v61, v2
    v_mul_f32 v62, v62, v2
    v_mul_f32 v63, v63, v2
    v_cvt_pk_bf16_f32 v64, v48, v49
    v_cvt_pk_bf16_f32 v65, v50, v51
    v_cvt_pk_bf16_f32 v66, v52, v53
    v_cvt_pk_bf16_f32 v67, v54, v55
    v_cvt_pk_bf16_f32 v68, v56, v57
    v_cvt_pk_bf16_f32 v69, v58, v59
    v_cvt_pk_bf16_f32 v70, v60, v61
    v_cvt_pk_bf16_f32 v71, v62, v63
    v_bfi_b32 v64, s69, v44, v64
    v_bfi_b32 v65, s69, v45, v65
    v_bfi_b32 v66, s69, v46, v66
    v_bfi_b32 v67, s69, v47, v67
    v_bfi_b32 v68, s69, v44, v68
    v_bfi_b32 v69, s69, v45, v69
    v_bfi_b32 v70, s69, v46, v70
    v_bfi_b32 v71, s69, v47, v71
    s_cmp_lg_u32 s77, 0
    s_cbranch_scc1 L_slowP
    buffer_store_dwordx4 v[64:67], v10, s[52:55], s57 offen offset:0
    buffer_store_dwordx4 v[68:71], v10, s[52:55], s57 offen offset:1024
    ds_read_b64 v[40:41], v9 offset:96
L_w_18:
    s_waitcnt lgkmcnt(0)
    v_or_b32 v40, v40, v41
    v_cmp_ne_u32 vcc, 0, v40
    s_cbranch_vccz L_w_18_ok
    ds_read_b64 v[40:41], v9 offset:96
    s_add_i32 s78, s78, -1
    s_cmp_gt_i32 s78, 0
    s_cbranch_scc1 L_w_18
L_w_18_ok:
L_pp:
    buffer_load_dwordx4 v[80:83], v10, s[52:55], s64 offen offset:0 sc1
    buffer_load_dwordx4 v[84:87], v10, s[52:55], s64 offen offset:1024 sc1
    buffer_load_dwordx4 v[88:91], v10, s[52:55], s65 offen offset:0 sc1
    buffer_load_dwordx4 v[92:95], v10, s[52:55], s65 offen offset:1024 sc1
    buffer_load_dwordx4 v[96:99], v10, s[52:55], s66 offen offset:0 sc1
    buffer_load_dwordx4 v[100:103], v10, s[52:55], s66 offen offset:1024 sc1
    buffer_load_dwordx4 v[104:107], v10, s[52:55], s67 offen offset:0 sc1
    buffer_load_dwordx4 v[108:111], v10, s[52:55], s67 offen offset:1024 sc1
    s_waitcnt vmcnt(7)
    v_xor_b32 v1, v80, v44
    v_bitop3_b32 v1, v1, v81, v45 bitop3:0xf6
    v_bitop3_b32 v1, v1, v82, v46 bitop3:0xf6
    v_bitop3_b32 v1, v1, v83, v47 bitop3:0xf6
    s_waitcnt vmcnt(6)
    v_bitop3_b32 v1, v1, v84, v44 bitop3:0xf6
    v_bitop3_b32 v1, v1, v85, v45 bitop3:0xf6
    v_bitop3_b32 v1, v1, v86, v46 bitop3:0xf6
    v_bitop3_b32 v1, v1, v87, v47 bitop3:0xf6
    s_waitcnt vmcnt(5)
    v_bitop3_b32 v1, v1, v88, v44 bitop3:0xf6
    v_bitop3_b32 v1, v1, v89, v45 bitop3:0xf6
    v_bitop3_b32 v1, v1, v90, v46 bitop3:0xf6
    v_bitop3_b32 v1, v1, v91, v47 bitop3:0xf6
    s_waitcnt vmcnt(4)
    v_bitop3_b32 v1, v1, v92, v44 bitop3:0xf6
    v_bitop3_b32 v1, v1, v93, v45 bitop3:0xf6
    v_bitop3_b32 v1, v1, v94, v46 bitop3:0xf6
    v_bitop3_b32 v1, v1, v95, v47 bitop3:0xf6
    s_waitcnt vmcnt(3)
    v_bitop3_b32 v1, v1, v96, v44 bitop3:0xf6
    v_bitop3_b32 v1, v1, v97, v45 bitop3:0xf6
    v_bitop3_b32 v1, v1, v98, v46 bitop3:0xf6
    v_bitop3_b32 v1, v1, v99, v47 bitop3:0xf6
    s_waitcnt vmcnt(2)
    v_bitop3_b32 v1, v1, v100, v44 bitop3:0xf6
    v_bitop3_b32 v1, v1, v101, v45 bitop3:0xf6
    v_bitop3_b32 v1, v1, v102, v46 bitop3:0xf6
    v_bitop3_b32 v1, v1, v103, v47 bitop3:0xf6
    s_waitcnt vmcnt(1)
    v_bitop3_b32 v1, v1, v104, v44 bitop3:0xf6
    v_bitop3_b32 v1, v1, v105, v45 bitop3:0xf6
    v_bitop3_b32 v1, v1, v106, v46 bitop3:0xf6
    v_bitop3_b32 v1, v1, v107, v47 bitop3:0xf6
    s_waitcnt vmcnt(0)
    v_bitop3_b32 v1, v1, v108, v44 bitop3:0xf6
    v_bitop3_b32 v1, v1, v109, v45 bitop3:0xf6
    v_bitop3_b32 v1, v1, v110, v46 bitop3:0xf6
    v_bitop3_b32 v1, v1, v111, v47 bitop3:0xf6
    v_and_b32 v1, 3221274624, v1
    v_cmp_ne_u32 vcc, 0, v1
    s_cbranch_vccz L_pp_ok
    s_add_i32 s78, s78, -1
    s_cmp_gt_i32 s78, 0
    s_cbranch_scc1 L_pp
L_pp_ok:
L_haveP:
    v_bfi_b32 v80, s69, 0, v80
    v_bfi_b32 v81, s69, 0, v81
    v_bfi_b32 v82, s69, 0, v82
    v_bfi_b32 v83, s69, 0, v83
    ds_write_b128 v16, v[80:83] offset:0
    v_bfi_b32 v84, s69, 0, v84
    v_bfi_b32 v85, s69, 0, v85
    v_bfi_b32 v86, s69, 0, v86
    v_bfi_b32 v87, s69, 0, v87
    ds_write_b128 v16, v[84:87] offset:1024
    v_bfi_b32 v88, s69, 0, v88
    v_bfi_b32 v89, s69, 0, v89
    v_bfi_b32 v90, s69, 0, v90
    v_bfi_b32 v91, s69, 0, v91
    ds_write_b128 v16, v[88:91] offset:2048
    v_bfi_b32 v92, s69, 0, v92
    v_bfi_b32 v93, s69, 0, v93
    v_bfi_b32 v94, s69, 0, v94
    v_bfi_b32 v95, s69, 0, v95
    ds_write_b128 v16, v[92:95] offset:3072
    v_bfi_b32 v96, s69, 0, v96
    v_bfi_b32 v97, s69, 0, v97
    v_bfi_b32 v98, s69, 0, v98
    v_bfi_b32 v99, s69, 0, v99
    ds_write_b128 v16, v[96:99] offset:4096
    v_bfi_b32 v100, s69, 0, v100
    v_bfi_b32 v101, s69, 0, v101
    v_bfi_b32 v102, s69, 0, v102
    v_bfi_b32 v103, s69, 0, v103
    ds_write_b128 v16, v[100:103] offset:5120
    v_bfi_b32 v104, s69, 0, v104
    v_bfi_b32 v105, s69, 0, v105
    v_bfi_b32 v106, s69, 0, v106
    v_bfi_b32 v107, s69, 0, v107
    ds_write_b128 v16, v[104:107] offset:6144
    v_bfi_b32 v108, s69, 0, v108
    v_bfi_b32 v109, s69, 0, v109
    v_bfi_b32 v110, s69, 0, v110
    v_bfi_b32 v111, s69, 0, v111
    ds_write_b128 v16, v[108:111] offset:7168
    s_mov_b64 exec, 1
    ds_write_b32 v8, v9 offset:264
    s_mov_b64 exec, -1
    v_and_b32 v11, 15, v0
    v_lshlrev_b32 v11, 7, v11
    s_and_b32 s64, s2, 0xf0
    s_lshl_b32 s64, s64, 7
    s_add_u32 s64, s64, s63
    s_add_u32 s64, s64, 8
    s_cmp_eq_u32 s79, 0
    s_cbranch_scc1 L_h0
    ds_read_b128 v[40:43], v9 offset:528
L_w_19:
    s_waitcnt lgkmcnt(0)
    v_xor_b32 v40, 255, v40
    v_cmp_ne_u32 vcc, 0, v40
    s_cbranch_vccz L_w_19_ok
    ds_read_b128 v[40:43], v9 offset:528
    s_add_i32 s78, s78, -1
    s_cmp_gt_i32 s78, 0
    s_cbranch_scc1 L_w_19
L_w_19_ok:
    s_mov_b64 exec, 1
    buffer_store_dwordx2 v[18:19], v9, s[52:55], s60 offen sc1
    s_mov_b64 exec, -1
    ds_read_b64 v[40:41], v9 offset:136
L_w_20:
    s_waitcnt lgkmcnt(0)
    v_or_b32 v40, v40, v41
    v_cmp_ne_u32 vcc, 0, v40
    s_cbranch_vccz L_w_20_ok
    ds_read_b64 v[40:41], v9 offset:136
    s_add_i32 s78, s78, -1
    s_cmp_gt_i32 s78, 0
    s_cbranch_scc1 L_w_20
L_w_20_ok:
    v_mov_b32 v24, 0
L_c2b:
    v_cmp_ne_u64 vcc, s[72:73], v[24:25]
    s_cbranch_vccz L_c2b_ok
    buffer_load_dwordx2 v[24:25], v11, s[52:55], s64 offen sc1
    s_waitcnt vmcnt(0)
    s_add_i32 s78, s78, -1
    s_cmp_gt_i32 s78, 0
    s_cbranch_scc1 L_c2b
L_c2b_ok:
    ds_write_b32 v9, v9 offset:272
    s_branch L_hend
L_h0:
    s_setprio 0
    v_and_b32 v1, 31, v0
    v_lshrrev_b32 v2, 5, v0
    v_mul_u32_u24 v2, 8*24576, v2
    v_lshl_add_u32 v34, v1, 4, v2
    v_lshrrev_b32 v3, 3, v1
    s_and_b32 s49, s22, 1
    s_lshl_b32 s61, s49, 9
    s_add_u32 s61, s61, 2048
    s_and_b32 s62, s2, 0xf0
    s_lshl_b32 s49, s49, 6
    s_add_u32 s49, s49, 256
    s_branch L_reduce
L_hend:
    s_waitcnt lgkmcnt(0)
    s_endpgm
L_slowS:
    s_xor_b32 s68, s58, 262144
L_so:
    buffer_load_dwordx4 v[64:67], v10, s[52:55], s68 offen offset:0 sc1
    buffer_load_dwordx4 v[68:71], v10, s[52:55], s68 offen offset:1024 sc1
    buffer_load_dwordx4 v[72:75], v10, s[52:55], s68 offen offset:2048 sc1
    buffer_load_dwordx4 v[76:79], v10, s[52:55], s68 offen offset:3072 sc1
    s_waitcnt vmcnt(3)
    v_xor_b32 v1, v64, v44
    v_bitop3_b32 v1, v1, v65, v45 bitop3:0xf6
    v_bitop3_b32 v1, v1, v66, v46 bitop3:0xf6
    v_bitop3_b32 v1, v1, v67, v47 bitop3:0xf6
    s_waitcnt vmcnt(2)
    v_bitop3_b32 v1, v1, v68, v44 bitop3:0xf6
    v_bitop3_b32 v1, v1, v69, v45 bitop3:0xf6
    v_bitop3_b32 v1, v1, v70, v46 bitop3:0xf6
    v_bitop3_b32 v1, v1, v71, v47 bitop3:0xf6
    s_waitcnt vmcnt(1)
    v_bitop3_b32 v1, v1, v72, v44 bitop3:0xf6
    v_bitop3_b32 v1, v1, v73, v45 bitop3:0xf6
    v_bitop3_b32 v1, v1, v74, v46 bitop3:0xf6
    v_bitop3_b32 v1, v1, v75, v47 bitop3:0xf6
    s_waitcnt vmcnt(0)
    v_bitop3_b32 v1, v1, v76, v44 bitop3:0xf6
    v_bitop3_b32 v1, v1, v77, v45 bitop3:0xf6
    v_bitop3_b32 v1, v1, v78, v46 bitop3:0xf6
    v_bitop3_b32 v1, v1, v79, v47 bitop3:0xf6
    v_and_b32 v1, 255, v1
    v_cmp_ne_u32 vcc, 0, v1
    s_cbranch_vccz L_so_ok
    s_add_i32 s78, s78, -1
    s_cmp_gt_i32 s78, 0
    s_cbranch_scc1 L_so
L_so_ok:
    s_add_u32 s68, s68, 2097152
    s_add_u32 s58, s58, 2097152
    buffer_store_dwordx4 v[64:67], v10, s[52:55], s68 offen offset:0 sc1
    buffer_store_dwordx4 v[68:71], v10, s[52:55], s68 offen offset:1024 sc1
    buffer_store_dwordx4 v[72:75], v10, s[52:55], s68 offen offset:2048 sc1
    buffer_store_dwordx4 v[76:79], v10, s[52:55], s68 offen offset:3072 sc1
    s_add_u32 s61, s59, 2097152
    s_waitcnt vmcnt(0)
    s_mov_b64 exec, 1
    buffer_store_dwordx2 v[18:19], v9, s[52:55], s61 offen sc1
    s_mov_b64 exec, -1
    s_xor_b32 s61, s61, 0x2000
    v_mov_b32 v1, 0
    v_mov_b32 v24, 0
L_hs:
    v_cmp_ne_u64 vcc, s[72:73], v[24:25]
    s_cbranch_vccz L_hs_ok
    buffer_load_dwordx2 v[24:25], v1, s[52:55], s61 offen sc1
    s_waitcnt vmcnt(0)
    s_add_i32 s78, s78, -1
    s_cmp_gt_i32 s78, 0
    s_cbranch_scc1 L_hs
L_hs_ok:
    buffer_load_dwordx4 v[64:67], v10, s[52:55], s58 offen offset:0 sc1
    buffer_load_dwordx4 v[68:71], v10, s[52:55], s58 offen offset:1024 sc1
    buffer_load_dwordx4 v[72:75], v10, s[52:55], s58 offen offset:2048 sc1
    buffer_load_dwordx4 v[76:79], v10, s[52:55], s58 offen offset:3072 sc1
    s_waitcnt vmcnt(0)
    s_branch L_haveS
L_slowP:
    s_add_u32 s57, s57, 4194304
    s_add_u32 s64, s64, 4194304
    s_add_u32 s65, s65, 4194304
    s_add_u32 s66, s66, 4194304
    s_add_u32 s67, s67, 4194304
    buffer_store_dwordx4 v[64:67], v10, s[52:55], s57 offen offset:0 sc1
    buffer_store_dwordx4 v[68:71], v10, s[52:55], s57 offen offset:1024 sc1
    s_add_u32 s61, s59, 3145728
    s_waitcnt vmcnt(0)
    s_mov_b64 exec, 1
    buffer_store_dwordx2 v[18:19], v9, s[52:55], s61 offen sc1
    s_mov_b64 exec, -1
    s_andn2_b32 s61, s61, 0x1800
    v_and_b32 v1, 3, v0
    v_lshlrev_b32 v1, 11, v1
    v_mov_b32 v24, 0
L_hp:
    v_cmp_ne_u64 vcc, s[72:73], v[24:25]
    s_cbranch_vccz L_hp_ok
    buffer_load_dwordx2 v[24:25], v1, s[52:55], s61 offen sc1
    s_waitcnt vmcnt(0)
    s_add_i32 s78, s78, -1
    s_cmp_gt_i32 s78, 0
    s_cbranch_scc1 L_hp
L_hp_ok:
    buffer_load_dwordx4 v[80:83], v10, s[52:55], s64 offen offset:0 sc1
    buffer_load_dwordx4 v[84:87], v10, s[52:55], s64 offen offset:1024 sc1
    buffer_load_dwordx4 v[88:91], v10, s[52:55], s65 offen offset:0 sc1
    buffer_load_dwordx4 v[92:95], v10, s[52:55], s65 offen offset:1024 sc1
    buffer_load_dwordx4 v[96:99], v10, s[52:55], s66 offen offset:0 sc1
    buffer_load_dwordx4 v[100:103], v10, s[52:55], s66 offen offset:1024 sc1
    buffer_load_dwordx4 v[104:107], v10, s[52:55], s67 offen offset:0 sc1
    buffer_load_dwordx4 v[108:111], v10, s[52:55], s67 offen offset:1024 sc1
    s_waitcnt vmcnt(0)
    s_branch L_haveP
    .p2align 6
L_compute:
    s_setprio 2
    s_sub_u32 s3, s3, 4
    v_mov_b32 v15, 0
    s_lshl_b32 m0, s3, 2
    v_bfrev_b32 v14, 2
    v_mov_b32 v11, m0
    s_mov_b32 m0, 0xffff
    s_getpc_b64 s[60:61]
L_pc:
    s_add_u32 s60, s60, L_start-L_pc
    s_addc_u32 s61, s61, -1
    s_lshr_b32 s62, s2, 3
    s_lshl_b32 s62, s62, 2
    s_add_u32 s62, s62, s3
    s_lshl_b32 s62, s62, 7
    s_add_u32 s62, s62, 60
    s_min_u32 s63, s62, L_end-L_start-4
    s_load_dwordx2 s[66:67], s[60:61], s63
    s_add_u32 s62, s62, 16384
    s_min_u32 s62, s62, L_end-L_start-4
    s_load_dwordx2 s[68:69], s[60:61], s62
    s_barrier
    s_and_b32 s76, s3, 1
    s_lshr_b32 s77, s3, 1
    v_bfe_u32 v5, v0, 2, 2
    v_lshrrev_b32 v6, 5, v0
    v_lshl_add_u32 v1, v6, 3, v5
    v_lshrrev_b32 v2, 1, v5
    v_bfe_u32 v3, v0, 4, 1
    v_and_b32 v5, 1, v0
    v_lshlrev_b32 v5, 4, v5
    v_and_b32 v7, 2, v0
    v_lshl_or_b32 v4, v7, 2, v5
    v_lshl_add_u32 v4, v3, 5, v4
    v_lshl_add_u32 v4, v2, 6, v4
    v_lshl_add_u32 v5, v1, 7, v4
    v_mad_u32_u24 v4, v1, s75, v4
    s_lshl_b32 s61, s77, 6
    v_xor_b32 v7, s61, v5
    s_lshl_b32 s61, s77, 13
    v_add_u32 v5, s61, v5
    v_and_b32 v9, 31, v0
    v_bfe_u32 v8, v0, 1, 3
    v_xor_b32 v8, v8, v6
    v_lshlrev_b32 v8, 4, v8
    v_lshl_add_u32 v8, v9, 7, v8
    v_bfe_u32 v2, v0, 3, 2
    v_mul_u32_u24 v2, 3072, v2
    v_lshl_add_u32 v2, v6, 7, v2
    v_and_b32 v9, 7, v0
    v_lshl_add_u32 v13, v9, 4, v2
    v_lshlrev_b32 v10, 4, v0
    s_lshl_b32 s61, s76, 13
    s_add_u32 s61, s61, 147456
    v_add_u32 v6, s61, v10
    s_lshl_b32 s61, s76, 2
    v_mov_b32 v9, s61
    s_mov_b32 s54, 33554432
    s_mov_b32 s55, 0x20000
    s_lshl_b32 s60, s2, 1
    s_add_u32 s60, s60, s76
    s_mul_i32 s57, s60, 12288
    s_add_u32 s57, s57, 16777216
    s_lshl_b32 s61, s77, 9
    s_add_u32 s58, s57, s61
    s_add_u32 s57, s58, s61
    s_add_u32 s58, s58, 2048
    s_lshl_b32 s59, s60, 12
    s_add_u32 s59, s59, 2097152
    s_mov_b32 s56, 0
    v_mov_b32 v128, 0
    v_mov_b32 v129, 0
    v_mov_b32 v130, 0
    v_mov_b32 v131, 0
    v_mov_b32 v132, 0
    v_mov_b32 v133, 0
    v_mov_b32 v134, 0
    v_mov_b32 v135, 0
    v_mov_b32 v136, 0
    v_mov_b32 v137, 0
    v_mov_b32 v138, 0
    v_mov_b32 v139, 0
    v_mov_b32 v140, 0
    v_mov_b32 v141, 0
    v_mov_b32 v142, 0
    v_mov_b32 v143, 0
    v_mov_b32 v144, 0
    v_mov_b32 v145, 0
    v_mov_b32 v146, 0
    v_mov_b32 v147, 0
    v_mov_b32 v148, 0
    v_mov_b32 v149, 0
    v_mov_b32 v150, 0
    v_mov_b32 v151, 0
    v_mov_b32 v152, 0
    v_mov_b32 v153, 0
    v_mov_b32 v154, 0
    v_mov_b32 v155, 0
    v_mov_b32 v156, 0
    v_mov_b32 v157, 0
    v_mov_b32 v158, 0
    v_mov_b32 v159, 0
    v_mov_b32 v160, 0
    v_mov_b32 v161, 0
    v_mov_b32 v162, 0
    v_mov_b32 v163, 0
    v_mov_b32 v164, 0
    v_mov_b32 v165, 0
    v_mov_b32 v166, 0
    v_mov_b32 v167, 0
    v_mov_b32 v168, 0
    v_mov_b32 v169, 0
    v_mov_b32 v170, 0
    v_mov_b32 v171, 0
    v_mov_b32 v172, 0
    v_mov_b32 v173, 0
    v_mov_b32 v174, 0
    v_mov_b32 v175, 0
    v_mov_b32 v176, 0
    v_mov_b32 v177, 0
    v_mov_b32 v178, 0
    v_mov_b32 v179, 0
    v_mov_b32 v180, 0
    v_mov_b32 v181, 0
    v_mov_b32 v182, 0
    v_mov_b32 v183, 0
    v_mov_b32 v184, 0
    v_mov_b32 v185, 0
    v_mov_b32 v186, 0
    v_mov_b32 v187, 0
    v_mov_b32 v188, 0
    v_mov_b32 v189, 0
    v_mov_b32 v190, 0
    v_mov_b32 v191, 0
    v_mov_b32 v192, 0
    v_mov_b32 v193, 0
    v_mov_b32 v194, 0
    v_mov_b32 v195, 0
    v_mov_b32 v196, 0
    v_mov_b32 v197, 0
    v_mov_b32 v198, 0
    v_mov_b32 v199, 0
    v_mov_b32 v200, 0
    v_mov_b32 v201, 0
    v_mov_b32 v202, 0
    v_mov_b32 v203, 0
    v_mov_b32 v204, 0
    v_mov_b32 v205, 0
    v_mov_b32 v206, 0
    v_mov_b32 v207, 0
    v_mov_b32 v208, 0
    v_mov_b32 v209, 0
    v_mov_b32 v210, 0
    v_mov_b32 v211, 0
    v_mov_b32 v212, 0
    v_mov_b32 v213, 0
    v_mov_b32 v214, 0
    v_mov_b32 v215, 0
    v_mov_b32 v216, 0
    v_mov_b32 v217, 0
    v_mov_b32 v218, 0
    v_mov_b32 v219, 0
    v_mov_b32 v220, 0
    v_mov_b32 v221, 0
    v_mov_b32 v222, 0
    v_mov_b32 v223, 0
    v_mov_b32 v240, -1
    v_mov_b32 v241, -1
    v_mov_b32 v242, -1
    v_mov_b32 v243, -1
    s_mov_b32 s60, s57
    s_waitcnt lgkmcnt(0)
    s_mov_b64 s[52:53], s[18:19]
    s_bitcmp1_b32 s21, 0
    s_mov_b32 s64, 135794178
    s_cmov_b32 s64, 471206914
    s_mov_b32 s65, 18
    s_cmov_b32 s65, 6
    s_mov_b32 s66, 236852232
    s_cmov_b32 s66, 35787272
    s_mov_b32 s67, 24
    s_cmov_b32 s67, 12
    s_mov_b32 s62, 34
    s_cmov_b32 s62, 16
    s_mov_b32 s63, 2
    s_cmov_b32 s63, 34
    s_mov_b32 s24, 17434372
    s_cmov_b32 s24, 117640715
    s_mov_b32 s25, 168234244
    s_cmov_b32 s25, 51251977
    s_mov_b32 s26, 135070977
    s_cmov_b32 s26, 235669767
    s_mov_b32 s27, 51384078
    s_cmov_b32 s27, 285609985
    s_mov_b32 s28, 269422854
    s_cmov_b32 s28, 101715201
    s_mov_b32 s29, 252121348
    s_cmov_b32 s29, 268569345
    s_mov_b32 s30, 151783686
    s_cmov_b32 s30, 33882637
    s_mov_b32 s31, 780
    s_cmov_b32 s31, 4357
    s_cmp_eq_u32 s77, 0
    s_cselect_b32 s62, s62, s63
    s_mul_i32 s63, s76, 3
    s_add_u32 s62, s62, s63
    s_lshl_b32 s62, s62, 8
    s_add_u32 s67, s67, s62
    s_add_u32 s67, s67, s3
    s_mul_i32 s61, s3, 0x01010101
    s_add_u32 s66, s66, s61
    s_and_b32 s61, s64, 255
    v_lshl_add_u32 v248, s61, 12, v4
    s_and_b32 s62, s66, 255
    v_lshl_add_u32 v251, s62, 12, v8
    v_xor_b32 v249, 64, v248
    s_lshr_b64 s[64:65], s[64:65], 8
    v_xor_b32 v252, 32, v251
    s_lshr_b64 s[66:67], s[66:67], 8
    v_xor_b32 v253, 64, v251
    v_xor_b32 v254, 0x60, v251
    ds_read_b64 v[2:3], v15 offset:0
    s_waitcnt lgkmcnt(0)
L_c_21:
    v_cmp_ne_u64 vcc, 0, v[2:3]
    s_cbranch_vccz L_c_21_ok
    ds_read_b64 v[2:3], v15 offset:0
    s_add_i32 s78, s78, -1
    s_cmp_gt_i32 s78, 0
    s_waitcnt lgkmcnt(0)
    s_cbranch_scc1 L_c_21
L_c_21_ok:
    ds_read_b128 v[112:115], v251
    ds_read_b64_tr_b16 v[16:17], v248 offset:0
    ds_read_b64_tr_b16 v[18:19], v248 offset:1536
    ds_read_b64_tr_b16 v[20:21], v249 offset:0
    ds_read_b64_tr_b16 v[22:23], v249 offset:1536
    ds_read_b64_tr_b16 v[24:25], v248 offset:128
    ds_read_b64_tr_b16 v[26:27], v248 offset:1664
    ds_read_b64_tr_b16 v[28:29], v249 offset:128
    ds_read_b64_tr_b16 v[30:31], v249 offset:1664
    ds_read_b64_tr_b16 v[32:33], v248 offset:256
    ds_read_b64_tr_b16 v[34:35], v248 offset:1792
    ds_read_b64_tr_b16 v[36:37], v249 offset:256
    ds_read_b64_tr_b16 v[38:39], v249 offset:1792
    ds_read_b128 v[116:119], v252
    ds_read_b64_tr_b16 v[40:41], v248 offset:6144
    ds_read_b64_tr_b16 v[42:43], v248 offset:7680
    ds_read_b64_tr_b16 v[44:45], v249 offset:6144
    ds_read_b64_tr_b16 v[46:47], v249 offset:7680
    ds_read_b64_tr_b16 v[48:49], v248 offset:6272
    ds_read_b64_tr_b16 v[50:51], v248 offset:7808
    ds_read_b64_tr_b16 v[52:53], v249 offset:6272
    ds_read_b64_tr_b16 v[54:55], v249 offset:7808
    ds_read_b64_tr_b16 v[56:57], v248 offset:6400
    ds_read_b64_tr_b16 v[58:59], v248 offset:7936
    ds_read_b64_tr_b16 v[60:61], v249 offset:6400
    ds_read_b64_tr_b16 v[62:63], v249 offset:7936
    ds_read_b128 v[120:123], v253
    ds_read_b64_tr_b16 v[64:65], v248 offset:12288
    ds_read_b64_tr_b16 v[66:67], v248 offset:13824
    ds_read_b64_tr_b16 v[68:69], v249 offset:12288
    ds_read_b64_tr_b16 v[70:71], v249 offset:13824
    ds_read_b64_tr_b16 v[72:73], v248 offset:12416
    ds_read_b64_tr_b16 v[74:75], v248 offset:13952
    ds_read_b64_tr_b16 v[76:77], v249 offset:12416
    ds_read_b64_tr_b16 v[78:79], v249 offset:13952
L_p1:
    s_waitcnt lgkmcnt(15)
    v_mfma_f32_32x32x16_bf16 v[128:143], v[16:19], v[112:115], v[128:143]
    ds_read_b64_tr_b16 v[80:81], v248 offset:12544
    ds_read_b64_tr_b16 v[82:83], v248 offset:14080
    ds_read_b64_tr_b16 v[84:85], v249 offset:12544
    v_mfma_f32_32x32x16_bf16 v[144:159], v[20:23], v[112:115], v[144:159]
    ds_read_b64_tr_b16 v[86:87], v249 offset:14080
    ds_read_b128 v[124:127], v254
    ds_read_b64_tr_b16 v[88:89], v248 offset:18432
    v_mfma_f32_32x32x16_bf16 v[160:175], v[24:27], v[112:115], v[160:175]
    ds_read_b64_tr_b16 v[90:91], v248 offset:19968
    ds_read_b64_tr_b16 v[92:93], v249 offset:18432
    ds_read_b64_tr_b16 v[94:95], v249 offset:19968
    v_mfma_f32_32x32x16_bf16 v[176:191], v[28:31], v[112:115], v[176:191]
    ds_read_b64_tr_b16 v[96:97], v248 offset:18560
    ds_read_b64_tr_b16 v[98:99], v248 offset:20096
    ds_read_b64_tr_b16 v[100:101], v249 offset:18560
    v_mfma_f32_32x32x16_bf16 v[192:207], v[32:35], v[112:115], v[192:207]
    ds_read_b64_tr_b16 v[102:103], v249 offset:20096
    ds_read_b64_tr_b16 v[104:105], v248 offset:18688
    ds_read_b64_tr_b16 v[106:107], v248 offset:20224
    v_mfma_f32_32x32x16_bf16 v[208:223], v[36:39], v[112:115], v[208:223]
    ds_read_b64_tr_b16 v[108:109], v249 offset:18688
    ds_read_b64_tr_b16 v[110:111], v249 offset:20224
    v_mfma_f32_32x32x16_bf16 v[128:143], v[40:43], v[116:119], v[128:143]
    s_and_b32 s61, s64, 255
    v_lshl_add_u32 v248, s61, 12, v4
    s_and_b32 s62, s66, 255
    v_lshl_add_u32 v251, s62, 12, v8
    v_xor_b32 v249, 64, v248
    s_lshr_b64 s[64:65], s[64:65], 8
    v_mfma_f32_32x32x16_bf16 v[144:159], v[44:47], v[116:119], v[144:159]
    v_xor_b32 v252, 32, v251
    s_lshr_b64 s[66:67], s[66:67], 8
    v_xor_b32 v253, 64, v251
    v_xor_b32 v254, 0x60, v251
    s_waitcnt lgkmcnt(0)
    s_barrier
    v_mfma_f32_32x32x16_bf16 v[160:175], v[48:51], v[116:119], v[160:175]
    v_mfma_f32_32x32x16_bf16 v[176:191], v[52:55], v[116:119], v[176:191]
    ds_read_b64 v[2:3], v15 offset:8
    v_mfma_f32_32x32x16_bf16 v[192:207], v[56:59], v[116:119], v[192:207]
    s_add_u32 s56, s56, 1
    v_mfma_f32_32x32x16_bf16 v[208:223], v[60:63], v[116:119], v[208:223]
    s_waitcnt lgkmcnt(0)
L_c_22:
    v_cmp_ne_u64 vcc, 0, v[2:3]
    s_cbranch_vccz L_c_22_ok
    ds_read_b64 v[2:3], v15 offset:8
    s_add_i32 s78, s78, -1
    s_cmp_gt_i32 s78, 0
    s_waitcnt lgkmcnt(0)
    s_cbranch_scc1 L_c_22
L_c_22_ok:
    s_cmp_eq_u32 s56, 5
    s_cbranch_scc1 L_p1_tail
    v_mfma_f32_32x32x16_bf16 v[128:143], v[64:67], v[120:123], v[128:143]
    ds_read_b128 v[112:115], v251
    ds_read_b64_tr_b16 v[16:17], v248 offset:0
    ds_read_b64_tr_b16 v[18:19], v248 offset:1536
    v_add_u32 v15, 8, v15
    v_mfma_f32_32x32x16_bf16 v[144:159], v[68:71], v[120:123], v[144:159]
    ds_read_b64_tr_b16 v[20:21], v249 offset:0
    ds_read_b64_tr_b16 v[22:23], v249 offset:1536
    ds_read_b64_tr_b16 v[24:25], v248 offset:128
    v_mfma_f32_32x32x16_bf16 v[160:175], v[72:75], v[120:123], v[160:175]
    ds_read_b64_tr_b16 v[26:27], v248 offset:1664
    ds_read_b64_tr_b16 v[28:29], v249 offset:128
    ds_read_b64_tr_b16 v[30:31], v249 offset:1664
    v_mfma_f32_32x32x16_bf16 v[176:191], v[76:79], v[120:123], v[176:191]
    ds_read_b64_tr_b16 v[32:33], v248 offset:256
    ds_read_b64_tr_b16 v[34:35], v248 offset:1792
    ds_read_b64_tr_b16 v[36:37], v249 offset:256
    v_mfma_f32_32x32x16_bf16 v[192:207], v[80:83], v[120:123], v[192:207]
    ds_read_b64_tr_b16 v[38:39], v249 offset:1792
    ds_read_b128 v[116:119], v252
    ds_read_b64_tr_b16 v[40:41], v248 offset:6144
    v_mfma_f32_32x32x16_bf16 v[208:223], v[84:87], v[120:123], v[208:223]
    ds_read_b64_tr_b16 v[42:43], v248 offset:7680
    ds_read_b64_tr_b16 v[44:45], v249 offset:6144
    ds_read_b64_tr_b16 v[46:47], v249 offset:7680
    v_mfma_f32_32x32x16_bf16 v[128:143], v[88:91], v[124:127], v[128:143]
    ds_read_b64_tr_b16 v[48:49], v248 offset:6272
    ds_read_b64_tr_b16 v[50:51], v248 offset:7808
    ds_read_b64_tr_b16 v[52:53], v249 offset:6272
    v_mfma_f32_32x32x16_bf16 v[144:159], v[92:95], v[124:127], v[144:159]
    ds_read_b64_tr_b16 v[54:55], v249 offset:7808
    ds_read_b64_tr_b16 v[56:57], v248 offset:6400
    ds_read_b64_tr_b16 v[58:59], v248 offset:7936
    v_mfma_f32_32x32x16_bf16 v[160:175], v[96:99], v[124:127], v[160:175]
    ds_read_b64_tr_b16 v[60:61], v249 offset:6400
    ds_read_b64_tr_b16 v[62:63], v249 offset:7936
    ds_read_b128 v[120:123], v253
    v_mfma_f32_32x32x16_bf16 v[176:191], v[100:103], v[124:127], v[176:191]
    ds_read_b64_tr_b16 v[64:65], v248 offset:12288
    ds_read_b64_tr_b16 v[66:67], v248 offset:13824
    ds_read_b64_tr_b16 v[68:69], v249 offset:12288
    v_mfma_f32_32x32x16_bf16 v[192:207], v[104:107], v[124:127], v[192:207]
    ds_read_b64_tr_b16 v[70:71], v249 offset:13824
    ds_read_b64_tr_b16 v[72:73], v248 offset:12416
    ds_read_b64_tr_b16 v[74:75], v248 offset:13952
    v_mfma_f32_32x32x16_bf16 v[208:223], v[108:111], v[124:127], v[208:223]
    ds_read_b64_tr_b16 v[76:77], v249 offset:12416
    ds_read_b64_tr_b16 v[78:79], v249 offset:13952
    s_branch L_p1
L_p1_tail:
    ds_read_b128 v[244:247], v10 offset:1024
    ds_read_b128 v[16:19], v251 offset:0
    v_mfma_f32_32x32x16_bf16 v[128:143], v[64:67], v[120:123], v[128:143]
    ds_read_b128 v[20:23], v252 offset:0
    ds_read_b128 v[24:27], v253 offset:0
    ds_read_b128 v[28:31], v254 offset:0
    v_mov_b32 v15, 0
    v_mfma_f32_32x32x16_bf16 v[128:143], v[88:91], v[124:127], v[128:143]
    ds_read_b128 v[32:35], v251 offset:4096
    ds_read_b128 v[36:39], v252 offset:4096
    ds_read_b128 v[40:43], v253 offset:4096
    s_movk_i32 s75, 0xff
    v_mfma_f32_32x32x16_bf16 v[144:159], v[68:71], v[120:123], v[144:159]
    ds_read_b128 v[44:47], v254 offset:4096
    ds_read_b128 v[48:51], v251 offset:8192
    ds_read_b128 v[52:55], v252 offset:8192
    v_mfma_f32_32x32x16_bf16 v[144:159], v[92:95], v[124:127], v[144:159]
    ds_read_b128 v[56:59], v253 offset:8192
    ds_read_b128 v[60:63], v254 offset:8192
    v_mfma_f32_32x32x16_bf16 v[160:175], v[72:75], v[120:123], v[160:175]
    v_cvt_pk_bf16_f32 v128, v128, v129
    v_cvt_pk_bf16_f32 v129, v130, v131
    v_cvt_pk_bf16_f32 v130, v132, v133
    v_cvt_pk_bf16_f32 v131, v134, v135
    v_mfma_f32_32x32x16_bf16 v[160:175], v[96:99], v[124:127], v[160:175]
    v_cvt_pk_bf16_f32 v132, v136, v137
    v_cvt_pk_bf16_f32 v133, v138, v139
    v_cvt_pk_bf16_f32 v134, v140, v141
    v_cvt_pk_bf16_f32 v135, v142, v143
    s_waitcnt lgkmcnt(0)
    s_barrier
    v_mfma_f32_32x32x16_bf16 v[176:191], v[76:79], v[120:123], v[176:191]
    v_cvt_pk_bf16_f32 v144, v144, v145
    v_cvt_pk_bf16_f32 v145, v146, v147
    v_cvt_pk_bf16_f32 v146, v148, v149
    v_cvt_pk_bf16_f32 v147, v150, v151
    v_mfma_f32_32x32x16_bf16 v[176:191], v[100:103], v[124:127], v[176:191]
    v_cvt_pk_bf16_f32 v148, v152, v153
    v_cvt_pk_bf16_f32 v149, v154, v155
    v_cvt_pk_bf16_f32 v150, v156, v157
    v_cvt_pk_bf16_f32 v151, v158, v159
    v_mfma_f32_32x32x16_bf16 v[192:207], v[80:83], v[120:123], v[192:207]
    v_cvt_pk_bf16_f32 v160, v160, v161
    v_cvt_pk_bf16_f32 v161, v162, v163
    v_cvt_pk_bf16_f32 v162, v164, v165
    v_cvt_pk_bf16_f32 v163, v166, v167
    v_mfma_f32_32x32x16_bf16 v[192:207], v[104:107], v[124:127], v[192:207]
    v_cvt_pk_bf16_f32 v164, v168, v169
    v_cvt_pk_bf16_f32 v165, v170, v171
    v_cvt_pk_bf16_f32 v166, v172, v173
    v_cvt_pk_bf16_f32 v167, v174, v175
    v_mfma_f32_32x32x16_bf16 v[208:223], v[84:87], v[120:123], v[208:223]
    v_cvt_pk_bf16_f32 v176, v176, v177
    v_cvt_pk_bf16_f32 v177, v178, v179
    v_cvt_pk_bf16_f32 v178, v180, v181
    v_cvt_pk_bf16_f32 v179, v182, v183
    v_mfma_f32_32x32x16_bf16 v[208:223], v[108:111], v[124:127], v[208:223]
    v_cvt_pk_bf16_f32 v180, v184, v185
    v_cvt_pk_bf16_f32 v181, v186, v187
    v_cvt_pk_bf16_f32 v182, v188, v189
    v_cvt_pk_bf16_f32 v183, v190, v191
    v_mfma_f32_32x32x16_bf16 v[224:239], v[16:19], v[128:131], 0
    v_cvt_pk_bf16_f32 v192, v192, v193
    v_cvt_pk_bf16_f32 v193, v194, v195
    v_cvt_pk_bf16_f32 v194, v196, v197
    v_cvt_pk_bf16_f32 v195, v198, v199
    v_mfma_f32_32x32x16_bf16 v[224:239], v[20:23], v[132:135], v[224:239]
    v_cvt_pk_bf16_f32 v196, v200, v201
    v_cvt_pk_bf16_f32 v197, v202, v203
    v_cvt_pk_bf16_f32 v198, v204, v205
    v_cvt_pk_bf16_f32 v199, v206, v207
    v_mfma_f32_32x32x16_bf16 v[224:239], v[24:27], v[144:147], v[224:239]
    v_cvt_pk_bf16_f32 v208, v208, v209
    v_cvt_pk_bf16_f32 v209, v210, v211
    v_cvt_pk_bf16_f32 v210, v212, v213
    v_cvt_pk_bf16_f32 v211, v214, v215
    v_mfma_f32_32x32x16_bf16 v[224:239], v[28:31], v[148:151], v[224:239]
    v_cvt_pk_bf16_f32 v212, v216, v217
    v_cvt_pk_bf16_f32 v213, v218, v219
    v_cvt_pk_bf16_f32 v214, v220, v221
    v_cvt_pk_bf16_f32 v215, v222, v223
    v_mfma_f32_32x32x16_bf16 v[224:239], v[32:35], v[160:163], v[224:239]
    s_lshl_b32 s61, s76, 12
    v_add_u32 v8, s61, v8
    s_bfe_u32 s61, s24, 524288
    v_lshl_add_u32 v248, s61, 13, v5
    v_mfma_f32_32x32x16_bf16 v[224:239], v[36:39], v[164:167], v[224:239]
    s_bfe_u32 s62, s27, 524288
    v_lshl_add_u32 v251, s62, 13, v8
    v_xor_b32 v249, 64, v248
    v_mfma_f32_32x32x16_bf16 v[224:239], v[40:43], v[176:179], v[224:239]
    s_bfe_u32 s63, s30, 524288
    v_lshl_add_u32 v250, s63, 13, v7
    v_mfma_f32_32x32x16_bf16 v[224:239], v[44:47], v[180:183], v[224:239]
    v_xor_b32 v252, 32, v251
    v_mfma_f32_32x32x16_bf16 v[224:239], v[48:51], v[192:195], v[224:239]
    v_xor_b32 v253, 64, v251
    v_mfma_f32_32x32x16_bf16 v[224:239], v[52:55], v[196:199], v[224:239]
    v_xor_b32 v254, 0x60, v251
    ds_read_b64 v[2:3], v15 offset:48
    v_mfma_f32_32x32x16_bf16 v[224:239], v[56:59], v[208:211], v[224:239]
    v_mfma_f32_32x32x16_bf16 v[224:239], v[60:63], v[212:215], v[224:239]
    s_waitcnt lgkmcnt(0)
    v_cmp_ne_u64 vcc, 0, v[2:3]
    s_cbranch_vccz L_su0_rdy
    s_nop 7
    s_cmp_lg_u32 s77, s71
    s_cbranch_scc1 L_so1_g
    ds_write_b128 v6, v[224:227] offset:0
    ds_write_b128 v6, v[228:231] offset:1024
    ds_write_b128 v6, v[232:235] offset:2048
    ds_write_b128 v6, v[236:239] offset:3072
    s_mov_b64 exec, 1
    ds_write_b32 v9, v15 offset:256
    s_mov_b64 exec, -1
    s_branch L_so1_j
L_so1_g:
    v_bfi_b32 v224, s75, v244, v224
    v_bfi_b32 v225, s75, v245, v225
    v_bfi_b32 v226, s75, v246, v226
    v_bfi_b32 v227, s75, v247, v227
    buffer_store_dwordx4 v[224:227], v10, s[52:55], s59 offen offset:0
    v_bfi_b32 v228, s75, v244, v228
    v_bfi_b32 v229, s75, v245, v229
    v_bfi_b32 v230, s75, v246, v230
    v_bfi_b32 v231, s75, v247, v231
    buffer_store_dwordx4 v[228:231], v10, s[52:55], s59 offen offset:1024
    v_bfi_b32 v232, s75, v244, v232
    v_bfi_b32 v233, s75, v245, v233
    v_bfi_b32 v234, s75, v246, v234
    v_bfi_b32 v235, s75, v247, v235
    buffer_store_dwordx4 v[232:235], v10, s[52:55], s59 offen offset:2048
    v_bfi_b32 v236, s75, v244, v236
    v_bfi_b32 v237, s75, v245, v237
    v_bfi_b32 v238, s75, v246, v238
    v_bfi_b32 v239, s75, v247, v239
    buffer_store_dwordx4 v[236:239], v10, s[52:55], s59 offen offset:3072
    ds_read_b32 v2, v15
    ds_read_b32 v2, v15
    ds_read_b32 v2, v15
    ds_read_b32 v2, v15
    ds_read_b32 v2, v15
L_so1_j:
    ds_read_b64 v[2:3], v15 offset:48
    s_waitcnt lgkmcnt(0)
L_c_23:
    v_cmp_ne_u64 vcc, 0, v[2:3]
    s_cbranch_vccz L_c_23_ok
    ds_read_b64 v[2:3], v15 offset:48
    s_add_i32 s78, s78, -1
    s_cmp_gt_i32 s78, 0
    s_waitcnt lgkmcnt(0)
    s_cbranch_scc1 L_c_23
L_c_23_ok:
    ds_read_b128 v[112:115], v251
    ds_read_b64_tr_b16 v[64:65], v248 offset:0
    ds_read_b64_tr_b16 v[66:67], v248 offset:512
    ds_read_b64_tr_b16 v[68:69], v249 offset:0
    ds_read_b64_tr_b16 v[70:71], v249 offset:512
    ds_read_b64_tr_b16 v[72:73], v250 offset:0
    ds_read_b64_tr_b16 v[74:75], v250 offset:512
    ds_read_b128 v[116:119], v252
    ds_read_b64_tr_b16 v[76:77], v248 offset:2048
    ds_read_b64_tr_b16 v[78:79], v248 offset:2560
    ds_read_b64_tr_b16 v[80:81], v249 offset:2048
    ds_read_b64_tr_b16 v[82:83], v249 offset:2560
    ds_read_b64_tr_b16 v[84:85], v250 offset:2048
    ds_read_b64_tr_b16 v[86:87], v250 offset:2560
    ds_read_b128 v[120:123], v253
    ds_read_b64_tr_b16 v[88:89], v248 offset:4096
    ds_read_b64_tr_b16 v[90:91], v248 offset:4608
    ds_read_b64_tr_b16 v[92:93], v249 offset:4096
    ds_read_b64_tr_b16 v[94:95], v249 offset:4608
    ds_read_b64_tr_b16 v[96:97], v250 offset:4096
    ds_read_b64_tr_b16 v[98:99], v250 offset:4608
    ds_read_b32 v2, v15
    ds_read_b32 v2, v15
    ds_read_b32 v2, v15
    ds_read_b32 v2, v15
    ds_read_b32 v2, v15
    s_branch L_su0_j
L_su0_rdy:
    ds_read_b128 v[112:115], v251
    ds_read_b64_tr_b16 v[64:65], v248 offset:0
    ds_read_b64_tr_b16 v[66:67], v248 offset:512
    ds_read_b64_tr_b16 v[68:69], v249 offset:0
    ds_read_b64_tr_b16 v[70:71], v249 offset:512
    ds_read_b64_tr_b16 v[72:73], v250 offset:0
    ds_read_b64_tr_b16 v[74:75], v250 offset:512
    ds_read_b128 v[116:119], v252
    ds_read_b64_tr_b16 v[76:77], v248 offset:2048
    ds_read_b64_tr_b16 v[78:79], v248 offset:2560
    ds_read_b64_tr_b16 v[80:81], v249 offset:2048
    ds_read_b64_tr_b16 v[82:83], v249 offset:2560
    ds_read_b64_tr_b16 v[84:85], v250 offset:2048
    ds_read_b64_tr_b16 v[86:87], v250 offset:2560
    ds_read_b128 v[120:123], v253
    ds_read_b64_tr_b16 v[88:89], v248 offset:4096
    ds_read_b64_tr_b16 v[90:91], v248 offset:4608
    ds_read_b64_tr_b16 v[92:93], v249 offset:4096
    ds_read_b64_tr_b16 v[94:95], v249 offset:4608
    ds_read_b64_tr_b16 v[96:97], v250 offset:4096
    ds_read_b64_tr_b16 v[98:99], v250 offset:4608
    s_cmp_lg_u32 s77, s71
    s_cbranch_scc1 L_so2_g
    ds_write_b128 v6, v[224:227] offset:0
    ds_write_b128 v6, v[228:231] offset:1024
    ds_write_b128 v6, v[232:235] offset:2048
    ds_write_b128 v6, v[236:239] offset:3072
    s_mov_b64 exec, 1
    ds_write_b32 v9, v15 offset:256
    s_mov_b64 exec, -1
    s_branch L_so2_j
L_so2_g:
    v_bfi_b32 v224, s75, v244, v224
    v_bfi_b32 v225, s75, v245, v225
    v_bfi_b32 v226, s75, v246, v226
    v_bfi_b32 v227, s75, v247, v227
    buffer_store_dwordx4 v[224:227], v10, s[52:55], s59 offen offset:0
    v_bfi_b32 v228, s75, v244, v228
    v_bfi_b32 v229, s75, v245, v229
    v_bfi_b32 v230, s75, v246, v230
    v_bfi_b32 v231, s75, v247, v231
    buffer_store_dwordx4 v[228:231], v10, s[52:55], s59 offen offset:1024
    v_bfi_b32 v232, s75, v244, v232
    v_bfi_b32 v233, s75, v245, v233
    v_bfi_b32 v234, s75, v246, v234
    v_bfi_b32 v235, s75, v247, v235
    buffer_store_dwordx4 v[232:235], v10, s[52:55], s59 offen offset:2048
    v_bfi_b32 v236, s75, v244, v236
    v_bfi_b32 v237, s75, v245, v237
    v_bfi_b32 v238, s75, v246, v238
    v_bfi_b32 v239, s75, v247, v239
    buffer_store_dwordx4 v[236:239], v10, s[52:55], s59 offen offset:3072
    ds_read_b32 v2, v15
    ds_read_b32 v2, v15
    ds_read_b32 v2, v15
    ds_read_b32 v2, v15
    ds_read_b32 v2, v15
L_so2_j:
L_su0_j:
    s_waitcnt lgkmcnt(15)
    v_mfma_f32_32x32x16_bf16 v[16:31], v[112:115], v[64:67], 0
    ds_read_b128 v[124:127], v254
    ds_read_b64_tr_b16 v[100:101], v248 offset:6144
    ds_read_b64_tr_b16 v[102:103], v248 offset:6656
    v_mfma_f32_32x32x16_bf16 v[32:47], v[112:115], v[68:71], 0
    ds_read_b64_tr_b16 v[104:105], v249 offset:6144
    ds_read_b64_tr_b16 v[106:107], v249 offset:6656
    v_mfma_f32_32x32x16_bf16 v[48:63], v[112:115], v[72:75], 0
    ds_read_b64_tr_b16 v[108:109], v250 offset:6144
    ds_read_b64_tr_b16 v[110:111], v250 offset:6656
    ds_read_b64 v[2:3], v15 offset:56
    v_mfma_f32_32x32x16_bf16 v[16:31], v[116:119], v[76:79], v[16:31]
    s_bfe_u32 s61, s24, 524296
    v_lshl_add_u32 v248, s61, 13, v5
    s_bfe_u32 s62, s27, 524296
    v_lshl_add_u32 v251, s62, 13, v8
    v_xor_b32 v249, 64, v248
    s_waitcnt lgkmcnt(15)
    v_mfma_f32_32x32x16_bf16 v[32:47], v[116:119], v[80:83], v[32:47]
    s_bfe_u32 s63, s30, 524296
    v_lshl_add_u32 v250, s63, 13, v7
    v_xor_b32 v252, 32, v251
    v_mfma_f32_32x32x16_bf16 v[48:63], v[116:119], v[84:87], v[48:63]
    v_xor_b32 v253, 64, v251
    v_xor_b32 v254, 0x60, v251
    s_waitcnt lgkmcnt(0)
    ds_append v12 offset:320
L_c_24:
    v_cmp_ne_u64 vcc, 0, v[2:3]
    s_cbranch_vccz L_c_24_ok
    ds_read_b64 v[2:3], v15 offset:56
    s_add_i32 s78, s78, -1
    s_cmp_gt_i32 s78, 0
    s_waitcnt lgkmcnt(0)
    s_cbranch_scc1 L_c_24
L_c_24_ok:
    ds_read_b128 v[112:115], v251
    ds_read_b64_tr_b16 v[64:65], v248 offset:0
    v_mfma_f32_32x32x16_bf16 v[16:31], v[120:123], v[88:91], v[16:31]
    ds_read_b64_tr_b16 v[66:67], v248 offset:512
    ds_read_b64_tr_b16 v[68:69], v249 offset:0
    ds_read_b64_tr_b16 v[70:71], v249 offset:512
    ds_read_b64_tr_b16 v[72:73], v250 offset:0
    v_mfma_f32_32x32x16_bf16 v[32:47], v[120:123], v[92:95], v[32:47]
    ds_read_b64_tr_b16 v[74:75], v250 offset:512
    ds_read_b128 v[116:119], v252
    ds_read_b64_tr_b16 v[76:77], v248 offset:2048
    v_mfma_f32_32x32x16_bf16 v[48:63], v[120:123], v[96:99], v[48:63]
    ds_read_b64_tr_b16 v[78:79], v248 offset:2560
    ds_read_b64_tr_b16 v[80:81], v249 offset:2048
    ds_read_b64_tr_b16 v[82:83], v249 offset:2560
    v_mfma_f32_32x32x16_bf16 v[16:31], v[124:127], v[100:103], v[16:31]
    ds_read_b64_tr_b16 v[84:85], v250 offset:2048
    ds_read_b64_tr_b16 v[86:87], v250 offset:2560
    ds_read_b128 v[120:123], v253
    v_mfma_f32_32x32x16_bf16 v[32:47], v[124:127], v[104:107], v[32:47]
    ds_read_b64_tr_b16 v[88:89], v248 offset:4096
    ds_read_b64_tr_b16 v[90:91], v248 offset:4608
    ds_read_b64_tr_b16 v[92:93], v249 offset:4096
    v_mfma_f32_32x32x16_bf16 v[48:63], v[124:127], v[108:111], v[48:63]
    ds_read_b64_tr_b16 v[94:95], v249 offset:4608
    ds_read_b64_tr_b16 v[96:97], v250 offset:4096
    ds_read_b64_tr_b16 v[98:99], v250 offset:4608
    s_waitcnt lgkmcnt(15)
    v_mfma_f32_32x32x16_bf16 v[16:31], v[112:115], v[64:67], v[16:31]
    ds_read_b128 v[124:127], v254
    ds_read_b64_tr_b16 v[100:101], v248 offset:6144
    ds_read_b64_tr_b16 v[102:103], v248 offset:6656
    v_mfma_f32_32x32x16_bf16 v[32:47], v[112:115], v[68:71], v[32:47]
    ds_read_b64_tr_b16 v[104:105], v249 offset:6144
    ds_read_b64_tr_b16 v[106:107], v249 offset:6656
    s_waitcnt lgkmcnt(15)
    v_mfma_f32_32x32x16_bf16 v[48:63], v[112:115], v[72:75], v[48:63]
    ds_read_b64_tr_b16 v[108:109], v250 offset:6144
    ds_read_b64_tr_b16 v[110:111], v250 offset:6656
    ds_read_b64 v[2:3], v15 offset:64
    v_mfma_f32_32x32x16_bf16 v[16:31], v[116:119], v[76:79], v[16:31]
    s_bfe_u32 s61, s24, 524304
    v_lshl_add_u32 v248, s61, 13, v5
    s_bfe_u32 s62, s27, 524304
    v_lshl_add_u32 v251, s62, 13, v8
    v_xor_b32 v249, 64, v248
    s_waitcnt lgkmcnt(15)
    v_mfma_f32_32x32x16_bf16 v[32:47], v[116:119], v[80:83], v[32:47]
    s_bfe_u32 s63, s30, 524304
    v_lshl_add_u32 v250, s63, 13, v7
    v_xor_b32 v252, 32, v251
    v_mfma_f32_32x32x16_bf16 v[48:63], v[116:119], v[84:87], v[48:63]
    v_xor_b32 v253, 64, v251
    v_xor_b32 v254, 0x60, v251
    s_waitcnt lgkmcnt(0)
    ds_append v12 offset:336
L_c_25:
    v_cmp_ne_u64 vcc, 0, v[2:3]
    s_cbranch_vccz L_c_25_ok
    ds_read_b64 v[2:3], v15 offset:64
    s_add_i32 s78, s78, -1
    s_cmp_gt_i32 s78, 0
    s_waitcnt lgkmcnt(0)
    s_cbranch_scc1 L_c_25
L_c_25_ok:
    ds_read_b128 v[112:115], v251
    ds_read_b64_tr_b16 v[64:65], v248 offset:0
    v_mfma_f32_32x32x16_bf16 v[16:31], v[120:123], v[88:91], v[16:31]
    ds_read_b64_tr_b16 v[66:67], v248 offset:512
    ds_read_b64_tr_b16 v[68:69], v249 offset:0
    ds_read_b64_tr_b16 v[70:71], v249 offset:512
    ds_read_b64_tr_b16 v[72:73], v250 offset:0
    v_mfma_f32_32x32x16_bf16 v[32:47], v[120:123], v[92:95], v[32:47]
    ds_read_b64_tr_b16 v[74:75], v250 offset:512
    ds_read_b128 v[116:119], v252
    ds_read_b64_tr_b16 v[76:77], v248 offset:2048
    v_mfma_f32_32x32x16_bf16 v[48:63], v[120:123], v[96:99], v[48:63]
    ds_read_b64_tr_b16 v[78:79], v248 offset:2560
    ds_read_b64_tr_b16 v[80:81], v249 offset:2048
    ds_read_b64_tr_b16 v[82:83], v249 offset:2560
    v_mfma_f32_32x32x16_bf16 v[16:31], v[124:127], v[100:103], v[16:31]
    ds_read_b64_tr_b16 v[84:85], v250 offset:2048
    ds_read_b64_tr_b16 v[86:87], v250 offset:2560
    ds_read_b128 v[120:123], v253
    v_mfma_f32_32x32x16_bf16 v[32:47], v[124:127], v[104:107], v[32:47]
    ds_read_b64_tr_b16 v[88:89], v248 offset:4096
    ds_read_b64_tr_b16 v[90:91], v248 offset:4608
    ds_read_b64_tr_b16 v[92:93], v249 offset:4096
    v_mfma_f32_32x32x16_bf16 v[48:63], v[124:127], v[108:111], v[48:63]
    ds_read_b64_tr_b16 v[94:95], v249 offset:4608
    ds_read_b64_tr_b16 v[96:97], v250 offset:4096
    ds_read_b64_tr_b16 v[98:99], v250 offset:4608
    s_waitcnt lgkmcnt(15)
    v_mfma_f32_32x32x16_bf16 v[16:31], v[112:115], v[64:67], v[16:31]
    ds_read_b128 v[124:127], v254
    ds_read_b64_tr_b16 v[100:101], v248 offset:6144
    ds_read_b64_tr_b16 v[102:103], v248 offset:6656
    v_mfma_f32_32x32x16_bf16 v[32:47], v[112:115], v[68:71], v[32:47]
    ds_read_b64_tr_b16 v[104:105], v249 offset:6144
    ds_read_b64_tr_b16 v[106:107], v249 offset:6656
    s_waitcnt lgkmcnt(15)
    v_mfma_f32_32x32x16_bf16 v[48:63], v[112:115], v[72:75], v[48:63]
    ds_read_b64_tr_b16 v[108:109], v250 offset:6144
    ds_read_b64_tr_b16 v[110:111], v250 offset:6656
    ds_read_b64 v[2:3], v15 offset:72
    v_mfma_f32_32x32x16_bf16 v[16:31], v[116:119], v[76:79], v[16:31]
    s_bfe_u32 s61, s24, 524312
    v_lshl_add_u32 v248, s61, 13, v5
    s_bfe_u32 s62, s27, 524312
    v_lshl_add_u32 v251, s62, 13, v8
    s_waitcnt lgkmcnt(15)
    v_mfma_f32_32x32x16_bf16 v[32:47], v[116:119], v[80:83], v[32:47]
    v_xor_b32 v249, 64, v248
    v_xor_b32 v252, 32, v251
    v_mfma_f32_32x32x16_bf16 v[48:63], v[116:119], v[84:87], v[48:63]
    v_xor_b32 v253, 64, v251
    v_xor_b32 v254, 0x60, v251
    s_waitcnt lgkmcnt(0)
    ds_append v12 offset:352
L_c_26:
    v_cmp_ne_u64 vcc, 0, v[2:3]
    s_cbranch_vccz L_c_26_ok
    ds_read_b64 v[2:3], v15 offset:72
    s_add_i32 s78, s78, -1
    s_cmp_gt_i32 s78, 0
    s_waitcnt lgkmcnt(0)
    s_cbranch_scc1 L_c_26
L_c_26_ok:
    ds_read_b128 v[112:115], v251
    ds_read_b64_tr_b16 v[64:65], v248 offset:0
    v_mfma_f32_32x32x16_bf16 v[16:31], v[120:123], v[88:91], v[16:31]
    ds_read_b64_tr_b16 v[66:67], v248 offset:512
    ds_read_b64_tr_b16 v[68:69], v249 offset:0
    ds_read_b64_tr_b16 v[70:71], v249 offset:512
    buffer_store_dwordx4 v[240:243], v13, s[52:55], s57 offen offset:0 sc1
    v_mfma_f32_32x32x16_bf16 v[32:47], v[120:123], v[92:95], v[32:47]
    ds_read_b128 v[116:119], v252
    ds_read_b64_tr_b16 v[76:77], v248 offset:2048
    v_mfma_f32_32x32x16_bf16 v[48:63], v[120:123], v[96:99], v[48:63]
    ds_read_b64_tr_b16 v[78:79], v248 offset:2560
    ds_read_b64_tr_b16 v[80:81], v249 offset:2048
    v_mfma_f32_32x32x16_bf16 v[16:31], v[124:127], v[100:103], v[16:31]
    ds_read_b64_tr_b16 v[82:83], v249 offset:2560
    ds_read_b128 v[120:123], v253
    v_mfma_f32_32x32x16_bf16 v[32:47], v[124:127], v[104:107], v[32:47]
    ds_read_b64_tr_b16 v[88:89], v248 offset:4096
    ds_read_b64_tr_b16 v[90:91], v248 offset:4608
    v_mfma_f32_32x32x16_bf16 v[48:63], v[124:127], v[108:111], v[48:63]
    ds_read_b64_tr_b16 v[92:93], v249 offset:4096
    ds_read_b64_tr_b16 v[94:95], v249 offset:4608
    s_waitcnt lgkmcnt(12)
    v_mfma_f32_32x32x16_bf16 v[128:143], v[112:115], v[64:67], 0
    ds_read_b128 v[124:127], v254
    ds_read_b64_tr_b16 v[100:101], v248 offset:6144
    ds_read_b64_tr_b16 v[102:103], v248 offset:6656
    s_waitcnt lgkmcnt(13)
    v_mfma_f32_32x32x16_bf16 v[144:159], v[112:115], v[68:71], 0
    ds_read_b64_tr_b16 v[104:105], v249 offset:6144
    ds_read_b64_tr_b16 v[106:107], v249 offset:6656
    v_cvt_pk_bf16_f32 v160, v16, v17
    v_cvt_pk_bf16_f32 v161, v18, v19
    ds_read_b64 v[2:3], v15 offset:80
    s_waitcnt lgkmcnt(13)
    v_mfma_f32_32x32x16_bf16 v[128:143], v[116:119], v[76:79], v[128:143]
    s_bfe_u32 s61, s25, 524288
    v_lshl_add_u32 v248, s61, 13, v5
    s_bfe_u32 s62, s28, 524288
    v_lshl_add_u32 v251, s62, 13, v8
    v_xor_b32 v249, 64, v248
    v_xor_b32 v252, 32, v251
    s_waitcnt lgkmcnt(11)
    v_mfma_f32_32x32x16_bf16 v[144:159], v[116:119], v[80:83], v[144:159]
    v_xor_b32 v253, 64, v251
    v_xor_b32 v254, 0x60, v251
    v_cvt_pk_bf16_f32 v162, v20, v21
    s_waitcnt lgkmcnt(0)
    ds_append v12 offset:368
L_c_27:
    v_cmp_ne_u64 vcc, 0, v[2:3]
    s_cbranch_vccz L_c_27_ok
    ds_read_b64 v[2:3], v15 offset:80
    s_add_i32 s78, s78, -1
    s_cmp_gt_i32 s78, 0
    s_waitcnt lgkmcnt(0)
    s_cbranch_scc1 L_c_27
L_c_27_ok:
    ds_read_b128 v[112:115], v251
    ds_read_b64_tr_b16 v[64:65], v248 offset:0
    v_mfma_f32_32x32x16_bf16 v[128:143], v[120:123], v[88:91], v[128:143]
    ds_read_b64_tr_b16 v[66:67], v248 offset:512
    ds_read_b64_tr_b16 v[68:69], v249 offset:0
    ds_read_b64_tr_b16 v[70:71], v249 offset:512
    ds_read_b128 v[116:119], v252
    v_cvt_pk_bf16_f32 v163, v22, v23
    v_cvt_pk_bf16_f32 v164, v24, v25
    v_mfma_f32_32x32x16_bf16 v[144:159], v[120:123], v[92:95], v[144:159]
    ds_read_b64_tr_b16 v[76:77], v248 offset:2048
    ds_read_b64_tr_b16 v[78:79], v248 offset:2560
    ds_read_b64_tr_b16 v[80:81], v249 offset:2048
    v_cvt_pk_bf16_f32 v165, v26, v27
    v_cvt_pk_bf16_f32 v166, v28, v29
    v_mfma_f32_32x32x16_bf16 v[128:143], v[124:127], v[100:103], v[128:143]
    ds_read_b64_tr_b16 v[82:83], v249 offset:2560
    ds_read_b128 v[120:123], v253
    ds_read_b64_tr_b16 v[88:89], v248 offset:4096
    v_cvt_pk_bf16_f32 v167, v30, v31
    v_mfma_f32_32x32x16_bf16 v[144:159], v[124:127], v[104:107], v[144:159]
    ds_read_b64_tr_b16 v[90:91], v248 offset:4608
    ds_read_b64_tr_b16 v[92:93], v249 offset:4096
    ds_read_b64_tr_b16 v[94:95], v249 offset:4608
    buffer_store_dwordx4 v[240:243], v13, s[52:55], s57 offen offset:256 sc1
    s_waitcnt lgkmcnt(12)
    v_mfma_f32_32x32x16_bf16 v[128:143], v[112:115], v[64:67], v[128:143]
    ds_read_b128 v[124:127], v254
    ds_read_b64_tr_b16 v[100:101], v248 offset:6144
    ds_read_b64_tr_b16 v[102:103], v248 offset:6656
    s_waitcnt lgkmcnt(13)
    v_mfma_f32_32x32x16_bf16 v[144:159], v[112:115], v[68:71], v[144:159]
    ds_read_b64_tr_b16 v[104:105], v249 offset:6144
    ds_read_b64_tr_b16 v[106:107], v249 offset:6656
    v_cvt_pk_bf16_f32 v168, v32, v33
    v_cvt_pk_bf16_f32 v169, v34, v35
    ds_read_b64 v[2:3], v15 offset:88
    s_waitcnt lgkmcnt(13)
    v_mfma_f32_32x32x16_bf16 v[128:143], v[116:119], v[76:79], v[128:143]
    s_bfe_u32 s61, s25, 524296
    v_lshl_add_u32 v248, s61, 13, v5
    s_bfe_u32 s62, s28, 524296
    v_lshl_add_u32 v251, s62, 13, v8
    v_xor_b32 v249, 64, v248
    v_xor_b32 v252, 32, v251
    s_waitcnt lgkmcnt(11)
    v_mfma_f32_32x32x16_bf16 v[144:159], v[116:119], v[80:83], v[144:159]
    v_xor_b32 v253, 64, v251
    v_xor_b32 v254, 0x60, v251
    v_cvt_pk_bf16_f32 v170, v36, v37
    s_waitcnt lgkmcnt(0)
    ds_append v12 offset:384
L_c_28:
    v_cmp_ne_u64 vcc, 0, v[2:3]
    s_cbranch_vccz L_c_28_ok
    ds_read_b64 v[2:3], v15 offset:88
    s_add_i32 s78, s78, -1
    s_cmp_gt_i32 s78, 0
    s_waitcnt lgkmcnt(0)
    s_cbranch_scc1 L_c_28
L_c_28_ok:
    ds_read_b128 v[112:115], v251
    ds_read_b64_tr_b16 v[64:65], v248 offset:0
    v_mfma_f32_32x32x16_bf16 v[128:143], v[120:123], v[88:91], v[128:143]
    ds_read_b64_tr_b16 v[66:67], v248 offset:512
    ds_read_b64_tr_b16 v[68:69], v249 offset:0
    ds_read_b64_tr_b16 v[70:71], v249 offset:512
    ds_read_b128 v[116:119], v252
    v_cvt_pk_bf16_f32 v171, v38, v39
    v_cvt_pk_bf16_f32 v172, v40, v41
    v_mfma_f32_32x32x16_bf16 v[144:159], v[120:123], v[92:95], v[144:159]
    ds_read_b64_tr_b16 v[76:77], v248 offset:2048
    ds_read_b64_tr_b16 v[78:79], v248 offset:2560
    ds_read_b64_tr_b16 v[80:81], v249 offset:2048
    v_cvt_pk_bf16_f32 v173, v42, v43
    v_cvt_pk_bf16_f32 v174, v44, v45
    v_mfma_f32_32x32x16_bf16 v[128:143], v[124:127], v[100:103], v[128:143]
    ds_read_b64_tr_b16 v[82:83], v249 offset:2560
    ds_read_b128 v[120:123], v253
    ds_read_b64_tr_b16 v[88:89], v248 offset:4096
    v_cvt_pk_bf16_f32 v175, v46, v47
    v_mfma_f32_32x32x16_bf16 v[144:159], v[124:127], v[104:107], v[144:159]
    ds_read_b64_tr_b16 v[90:91], v248 offset:4608
    ds_read_b64_tr_b16 v[92:93], v249 offset:4096
    ds_read_b64_tr_b16 v[94:95], v249 offset:4608
    buffer_store_dwordx4 v[240:243], v13, s[52:55], s57 offen offset:512 sc1
    s_waitcnt lgkmcnt(12)
    v_mfma_f32_32x32x16_bf16 v[128:143], v[112:115], v[64:67], v[128:143]
    ds_read_b128 v[124:127], v254
    ds_read_b64_tr_b16 v[100:101], v248 offset:6144
    ds_read_b64_tr_b16 v[102:103], v248 offset:6656
    s_waitcnt lgkmcnt(13)
    v_mfma_f32_32x32x16_bf16 v[144:159], v[112:115], v[68:71], v[144:159]
    ds_read_b64_tr_b16 v[104:105], v249 offset:6144
    ds_read_b64_tr_b16 v[106:107], v249 offset:6656
    v_cvt_pk_bf16_f32 v176, v48, v49
    v_cvt_pk_bf16_f32 v177, v50, v51
    ds_read_b64 v[2:3], v15 offset:96
    s_waitcnt lgkmcnt(13)
    v_mfma_f32_32x32x16_bf16 v[128:143], v[116:119], v[76:79], v[128:143]
    s_bfe_u32 s61, s25, 524304
    v_lshl_add_u32 v248, s61, 13, v5
    s_bfe_u32 s62, s28, 524304
    v_lshl_add_u32 v251, s62, 13, v8
    v_xor_b32 v249, 64, v248
    s_bfe_u32 s63, s30, 524312
    v_lshl_add_u32 v250, s63, 13, v7
    s_waitcnt lgkmcnt(11)
    v_mfma_f32_32x32x16_bf16 v[144:159], v[116:119], v[80:83], v[144:159]
    v_xor_b32 v252, 32, v251
    v_xor_b32 v253, 64, v251
    v_xor_b32 v254, 0x60, v251
    s_waitcnt lgkmcnt(0)
    ds_append v12 offset:400
L_c_29:
    v_cmp_ne_u64 vcc, 0, v[2:3]
    s_cbranch_vccz L_c_29_ok
    ds_read_b64 v[2:3], v15 offset:96
    s_add_i32 s78, s78, -1
    s_cmp_gt_i32 s78, 0
    s_waitcnt lgkmcnt(0)
    s_cbranch_scc1 L_c_29
L_c_29_ok:
    ds_read_b128 v[112:115], v251
    ds_read_b64_tr_b16 v[64:65], v248 offset:0
    v_mfma_f32_32x32x16_bf16 v[128:143], v[120:123], v[88:91], v[128:143]
    ds_read_b64_tr_b16 v[66:67], v248 offset:512
    ds_read_b64_tr_b16 v[68:69], v249 offset:0
    ds_read_b64_tr_b16 v[70:71], v249 offset:512
    ds_read_b64_tr_b16 v[72:73], v250 offset:0
    ds_read_b64_tr_b16 v[74:75], v250 offset:512
    v_cvt_pk_bf16_f32 v178, v52, v53
    v_cvt_pk_bf16_f32 v179, v54, v55
    v_mfma_f32_32x32x16_bf16 v[144:159], v[120:123], v[92:95], v[144:159]
    ds_read_b128 v[116:119], v252
    ds_read_b64_tr_b16 v[76:77], v248 offset:2048
    ds_read_b64_tr_b16 v[78:79], v248 offset:2560
    ds_read_b64_tr_b16 v[80:81], v249 offset:2048
    ds_read_b64_tr_b16 v[82:83], v249 offset:2560
    v_cvt_pk_bf16_f32 v180, v56, v57
    v_cvt_pk_bf16_f32 v181, v58, v59
    v_mfma_f32_32x32x16_bf16 v[128:143], v[124:127], v[100:103], v[128:143]
    ds_read_b64_tr_b16 v[84:85], v250 offset:2048
    ds_read_b64_tr_b16 v[86:87], v250 offset:2560
    ds_read_b128 v[120:123], v253
    ds_read_b64_tr_b16 v[88:89], v248 offset:4096
    ds_read_b64_tr_b16 v[90:91], v248 offset:4608
    v_cvt_pk_bf16_f32 v182, v60, v61
    v_cvt_pk_bf16_f32 v183, v62, v63
    v_mfma_f32_32x32x16_bf16 v[144:159], v[124:127], v[104:107], v[144:159]
    ds_read_b64_tr_b16 v[92:93], v249 offset:4096
    ds_read_b64_tr_b16 v[94:95], v249 offset:4608
    ds_read_b64_tr_b16 v[96:97], v250 offset:4096
    ds_read_b64_tr_b16 v[98:99], v250 offset:4608
    buffer_store_dwordx4 v[240:243], v13, s[52:55], s57 offen offset:768 sc1
    s_waitcnt lgkmcnt(15)
    v_mfma_f32_32x32x16_bf16 v[16:31], v[112:115], v[64:67], 0
    ds_read_b128 v[124:127], v254
    ds_read_b64_tr_b16 v[100:101], v248 offset:6144
    ds_read_b64_tr_b16 v[102:103], v248 offset:6656
    v_mfma_f32_32x32x16_bf16 v[32:47], v[112:115], v[68:71], 0
    ds_read_b64_tr_b16 v[104:105], v249 offset:6144
    ds_read_b64_tr_b16 v[106:107], v249 offset:6656
    v_cvt_pk_bf16_f32 v184, v128, v129
    v_cvt_pk_bf16_f32 v185, v130, v131
    s_waitcnt lgkmcnt(15)
    v_mfma_f32_32x32x16_bf16 v[48:63], v[112:115], v[72:75], 0
    ds_read_b64_tr_b16 v[108:109], v250 offset:6144
    ds_read_b64_tr_b16 v[110:111], v250 offset:6656
    v_cvt_pk_bf16_f32 v186, v132, v133
    v_cvt_pk_bf16_f32 v187, v134, v135
    ds_read_b64 v[2:3], v15 offset:104
    v_mfma_f32_32x32x16_bf16 v[16:31], v[116:119], v[76:79], v[16:31]
    s_bfe_u32 s61, s25, 524312
    v_lshl_add_u32 v248, s61, 13, v5
    s_bfe_u32 s62, s28, 524312
    v_lshl_add_u32 v251, s62, 13, v8
    v_xor_b32 v249, 64, v248
    s_waitcnt lgkmcnt(15)
    v_mfma_f32_32x32x16_bf16 v[32:47], v[116:119], v[80:83], v[32:47]
    s_bfe_u32 s63, s31, 524288
    v_lshl_add_u32 v250, s63, 13, v7
    v_xor_b32 v252, 32, v251
    v_xor_b32 v253, 64, v251
    v_mfma_f32_32x32x16_bf16 v[48:63], v[116:119], v[84:87], v[48:63]
    v_xor_b32 v254, 0x60, v251
    v_cvt_pk_bf16_f32 v188, v136, v137
    v_cvt_pk_bf16_f32 v189, v138, v139
    s_waitcnt lgkmcnt(0)
    ds_append v12 offset:416
L_c_30:
    v_cmp_ne_u64 vcc, 0, v[2:3]
    s_cbranch_vccz L_c_30_ok
    ds_read_b64 v[2:3], v15 offset:104
    s_add_i32 s78, s78, -1
    s_cmp_gt_i32 s78, 0
    s_waitcnt lgkmcnt(0)
    s_cbranch_scc1 L_c_30
L_c_30_ok:
    ds_read_b128 v[112:115], v251
    ds_read_b64_tr_b16 v[64:65], v248 offset:0
    v_mfma_f32_32x32x16_bf16 v[16:31], v[120:123], v[88:91], v[16:31]
    ds_read_b64_tr_b16 v[66:67], v248 offset:512
    ds_read_b64_tr_b16 v[68:69], v249 offset:0
    ds_read_b64_tr_b16 v[70:71], v249 offset:512
    ds_read_b64_tr_b16 v[72:73], v250 offset:0
    buffer_store_dwordx4 v[240:243], v13, s[52:55], s58 offen offset:0 sc1
    v_mfma_f32_32x32x16_bf16 v[32:47], v[120:123], v[92:95], v[32:47]
    ds_read_b64_tr_b16 v[74:75], v250 offset:512
    ds_read_b128 v[116:119], v252
    ds_read_b64_tr_b16 v[76:77], v248 offset:2048
    v_mfma_f32_32x32x16_bf16 v[48:63], v[120:123], v[96:99], v[48:63]
    ds_read_b64_tr_b16 v[78:79], v248 offset:2560
    ds_read_b64_tr_b16 v[80:81], v249 offset:2048
    ds_read_b64_tr_b16 v[82:83], v249 offset:2560
    v_mfma_f32_32x32x16_bf16 v[16:31], v[124:127], v[100:103], v[16:31]
    ds_read_b64_tr_b16 v[84:85], v250 offset:2048
    ds_read_b64_tr_b16 v[86:87], v250 offset:2560
    ds_read_b128 v[120:123], v253
    v_mfma_f32_32x32x16_bf16 v[32:47], v[124:127], v[104:107], v[32:47]
    ds_read_b64_tr_b16 v[88:89], v248 offset:4096
    ds_read_b64_tr_b16 v[90:91], v248 offset:4608
    ds_read_b64_tr_b16 v[92:93], v249 offset:4096
    v_mfma_f32_32x32x16_bf16 v[48:63], v[124:127], v[108:111], v[48:63]
    ds_read_b64_tr_b16 v[94:95], v249 offset:4608
    ds_read_b64_tr_b16 v[96:97], v250 offset:4096
    ds_read_b64_tr_b16 v[98:99], v250 offset:4608
    s_waitcnt lgkmcnt(15)
    v_mfma_f32_32x32x16_bf16 v[16:31], v[112:115], v[64:67], v[16:31]
    ds_read_b128 v[124:127], v254
    ds_read_b64_tr_b16 v[100:101], v248 offset:6144
    ds_read_b64_tr_b16 v[102:103], v248 offset:6656
    v_mfma_f32_32x32x16_bf16 v[32:47], v[112:115], v[68:71], v[32:47]
    ds_read_b64_tr_b16 v[104:105], v249 offset:6144
    ds_read_b64_tr_b16 v[106:107], v249 offset:6656
    v_cvt_pk_bf16_f32 v190, v140, v141
    v_cvt_pk_bf16_f32 v191, v142, v143
    s_waitcnt lgkmcnt(15)
    v_mfma_f32_32x32x16_bf16 v[48:63], v[112:115], v[72:75], v[48:63]
    ds_read_b64_tr_b16 v[108:109], v250 offset:6144
    ds_read_b64_tr_b16 v[110:111], v250 offset:6656
    v_cvt_pk_bf16_f32 v192, v144, v145
    v_cvt_pk_bf16_f32 v193, v146, v147
    ds_read_b64 v[2:3], v15 offset:112
    v_mfma_f32_32x32x16_bf16 v[16:31], v[116:119], v[76:79], v[16:31]
    s_bfe_u32 s61, s26, 524288
    v_lshl_add_u32 v248, s61, 13, v5
    s_bfe_u32 s62, s29, 524288
    v_lshl_add_u32 v251, s62, 13, v8
    v_xor_b32 v249, 64, v248
    s_waitcnt lgkmcnt(15)
    v_mfma_f32_32x32x16_bf16 v[32:47], v[116:119], v[80:83], v[32:47]
    s_bfe_u32 s63, s31, 524296
    v_lshl_add_u32 v250, s63, 13, v7
    v_xor_b32 v252, 32, v251
    v_xor_b32 v253, 64, v251
    v_mfma_f32_32x32x16_bf16 v[48:63], v[116:119], v[84:87], v[48:63]
    v_xor_b32 v254, 0x60, v251
    v_cvt_pk_bf16_f32 v194, v148, v149
    s_waitcnt lgkmcnt(0)
L_c_31:
    v_cmp_ne_u64 vcc, 0, v[2:3]
    s_cbranch_vccz L_c_31_ok
    ds_read_b64 v[2:3], v15 offset:112
    s_add_i32 s78, s78, -1
    s_cmp_gt_i32 s78, 0
    s_waitcnt lgkmcnt(0)
    s_cbranch_scc1 L_c_31
L_c_31_ok:
    ds_read_b128 v[112:115], v251
    ds_read_b64_tr_b16 v[64:65], v248 offset:0
    v_mfma_f32_32x32x16_bf16 v[16:31], v[120:123], v[88:91], v[16:31]
    ds_read_b64_tr_b16 v[66:67], v248 offset:512
    ds_read_b64_tr_b16 v[68:69], v249 offset:0
    ds_read_b64_tr_b16 v[70:71], v249 offset:512
    ds_read_b64_tr_b16 v[72:73], v250 offset:0
    buffer_store_dwordx4 v[240:243], v13, s[52:55], s58 offen offset:256 sc1
    v_mfma_f32_32x32x16_bf16 v[32:47], v[120:123], v[92:95], v[32:47]
    ds_read_b64_tr_b16 v[74:75], v250 offset:512
    ds_read_b128 v[116:119], v252
    ds_read_b64_tr_b16 v[76:77], v248 offset:2048
    v_mfma_f32_32x32x16_bf16 v[48:63], v[120:123], v[96:99], v[48:63]
    ds_read_b64_tr_b16 v[78:79], v248 offset:2560
    ds_read_b64_tr_b16 v[80:81], v249 offset:2048
    ds_read_b64_tr_b16 v[82:83], v249 offset:2560
    v_mfma_f32_32x32x16_bf16 v[16:31], v[124:127], v[100:103], v[16:31]
    ds_read_b64_tr_b16 v[84:85], v250 offset:2048
    ds_read_b64_tr_b16 v[86:87], v250 offset:2560
    ds_read_b128 v[120:123], v253
    v_mfma_f32_32x32x16_bf16 v[32:47], v[124:127], v[104:107], v[32:47]
    ds_read_b64_tr_b16 v[88:89], v248 offset:4096
    ds_read_b64_tr_b16 v[90:91], v248 offset:4608
    ds_read_b64_tr_b16 v[92:93], v249 offset:4096
    v_mfma_f32_32x32x16_bf16 v[48:63], v[124:127], v[108:111], v[48:63]
    ds_read_b64_tr_b16 v[94:95], v249 offset:4608
    ds_read_b64_tr_b16 v[96:97], v250 offset:4096
    ds_read_b64_tr_b16 v[98:99], v250 offset:4608
    s_waitcnt lgkmcnt(15)
    v_mfma_f32_32x32x16_bf16 v[16:31], v[112:115], v[64:67], v[16:31]
    ds_read_b128 v[124:127], v254
    ds_read_b64_tr_b16 v[100:101], v248 offset:6144
    ds_read_b64_tr_b16 v[102:103], v248 offset:6656
    v_mfma_f32_32x32x16_bf16 v[32:47], v[112:115], v[68:71], v[32:47]
    ds_read_b64_tr_b16 v[104:105], v249 offset:6144
    ds_read_b64_tr_b16 v[106:107], v249 offset:6656
    v_cvt_pk_bf16_f32 v195, v150, v151
    v_cvt_pk_bf16_f32 v196, v152, v153
    s_waitcnt lgkmcnt(15)
    v_mfma_f32_32x32x16_bf16 v[48:63], v[112:115], v[72:75], v[48:63]
    ds_read_b64_tr_b16 v[108:109], v250 offset:6144
    ds_read_b64_tr_b16 v[110:111], v250 offset:6656
    v_cvt_pk_bf16_f32 v197, v154, v155
    v_cvt_pk_bf16_f32 v198, v156, v157
    ds_read_b64 v[2:3], v15 offset:120
    v_mfma_f32_32x32x16_bf16 v[16:31], v[116:119], v[76:79], v[16:31]
    s_bfe_u32 s61, s26, 524296
    v_lshl_add_u32 v248, s61, 13, v5
    s_bfe_u32 s62, s29, 524296
    v_lshl_add_u32 v251, s62, 13, v8
    v_xor_b32 v249, 64, v248
    s_waitcnt lgkmcnt(15)
    v_mfma_f32_32x32x16_bf16 v[32:47], v[116:119], v[80:83], v[32:47]
    v_xor_b32 v252, 32, v251
    v_xor_b32 v253, 64, v251
    v_mfma_f32_32x32x16_bf16 v[48:63], v[116:119], v[84:87], v[48:63]
    v_xor_b32 v254, 0x60, v251
    v_cvt_pk_bf16_f32 v199, v158, v159
    s_waitcnt lgkmcnt(0)
L_c_32:
    v_cmp_ne_u64 vcc, 0, v[2:3]
    s_cbranch_vccz L_c_32_ok
    ds_read_b64 v[2:3], v15 offset:120
    s_add_i32 s78, s78, -1
    s_cmp_gt_i32 s78, 0
    s_waitcnt lgkmcnt(0)
    s_cbranch_scc1 L_c_32
L_c_32_ok:
    ds_read_b128 v[112:115], v251
    ds_read_b64_tr_b16 v[64:65], v248 offset:0
    v_mfma_f32_32x32x16_bf16 v[16:31], v[120:123], v[88:91], v[16:31]
    ds_read_b64_tr_b16 v[66:67], v248 offset:512
    ds_read_b64_tr_b16 v[68:69], v249 offset:0
    ds_read_b64_tr_b16 v[70:71], v249 offset:512
    v_mfma_f32_32x32x16_bf16 v[32:47], v[120:123], v[92:95], v[32:47]
    ds_read_b128 v[116:119], v252
    ds_read_b64_tr_b16 v[76:77], v248 offset:2048
    v_mfma_f32_32x32x16_bf16 v[48:63], v[120:123], v[96:99], v[48:63]
    ds_read_b64_tr_b16 v[78:79], v248 offset:2560
    ds_read_b64_tr_b16 v[80:81], v249 offset:2048
    v_mfma_f32_32x32x16_bf16 v[16:31], v[124:127], v[100:103], v[16:31]
    ds_read_b64_tr_b16 v[82:83], v249 offset:2560
    ds_read_b128 v[120:123], v253
    v_mfma_f32_32x32x16_bf16 v[32:47], v[124:127], v[104:107], v[32:47]
    ds_read_b64_tr_b16 v[88:89], v248 offset:4096
    ds_read_b64_tr_b16 v[90:91], v248 offset:4608
    v_mfma_f32_32x32x16_bf16 v[48:63], v[124:127], v[108:111], v[48:63]
    ds_read_b64_tr_b16 v[92:93], v249 offset:4096
    ds_read_b64_tr_b16 v[94:95], v249 offset:4608
    s_waitcnt lgkmcnt(12)
    v_mfma_f32_32x32x16_bf16 v[128:143], v[112:115], v[64:67], 0
    ds_read_b128 v[124:127], v254
    ds_read_b64_tr_b16 v[100:101], v248 offset:6144
    ds_read_b64_tr_b16 v[102:103], v248 offset:6656
    s_waitcnt lgkmcnt(13)
    v_mfma_f32_32x32x16_bf16 v[144:159], v[112:115], v[68:71], 0
    ds_read_b64_tr_b16 v[104:105], v249 offset:6144
    ds_read_b64_tr_b16 v[106:107], v249 offset:6656
    v_cvt_pk_bf16_f32 v200, v16, v17
    v_cvt_pk_bf16_f32 v201, v18, v19
    ds_read_b32 v2, v9 offset:264
    s_waitcnt lgkmcnt(13)
    v_mfma_f32_32x32x16_bf16 v[128:143], v[116:119], v[76:79], v[128:143]
    v_cvt_pk_bf16_f32 v202, v20, v21
    v_cvt_pk_bf16_f32 v203, v22, v23
    v_cvt_pk_bf16_f32 v204, v24, v25
    v_cvt_pk_bf16_f32 v205, v26, v27
    s_waitcnt lgkmcnt(11)
    v_mfma_f32_32x32x16_bf16 v[144:159], v[116:119], v[80:83], v[144:159]
    v_cvt_pk_bf16_f32 v206, v28, v29
    v_cvt_pk_bf16_f32 v207, v30, v31
    v_cvt_pk_bf16_f32 v208, v32, v33
    s_waitcnt lgkmcnt(0)
L_c_33:
    v_cmp_ne_u32 vcc, 0, v2
    s_cbranch_vccz L_c_33_ok
    ds_read_b32 v2, v9 offset:264
    s_add_i32 s78, s78, -1
    s_cmp_gt_i32 s78, 0
    s_waitcnt lgkmcnt(0)
    s_cbranch_scc1 L_c_33
L_c_33_ok:
    s_waitcnt vmcnt(0)
    ds_read_b128 v[224:227], v6 offset:0
    ds_read_b128 v[228:231], v6 offset:1024
    v_mfma_f32_32x32x16_bf16 v[128:143], v[120:123], v[88:91], v[128:143]
    ds_read_b128 v[240:243], v6 offset:4096
    v_cvt_pk_bf16_f32 v209, v34, v35
    v_cvt_pk_bf16_f32 v210, v36, v37
    v_cvt_pk_bf16_f32 v211, v38, v39
    v_cvt_pk_bf16_f32 v212, v40, v41
    v_mfma_f32_32x32x16_bf16 v[144:159], v[120:123], v[92:95], v[144:159]
    ds_read_b128 v[244:247], v6 offset:5120
    v_cvt_pk_bf16_f32 v213, v42, v43
    v_cvt_pk_bf16_f32 v214, v44, v45
    v_cvt_pk_bf16_f32 v215, v46, v47
    v_cvt_pk_bf16_f32 v216, v48, v49
    v_mfma_f32_32x32x16_bf16 v[128:143], v[124:127], v[100:103], v[128:143]
    ds_read_b128 v[232:235], v6 offset:2048
    v_cvt_pk_bf16_f32 v217, v50, v51
    v_cvt_pk_bf16_f32 v218, v52, v53
    v_cvt_pk_bf16_f32 v219, v54, v55
    v_cvt_pk_bf16_f32 v220, v56, v57
    v_mfma_f32_32x32x16_bf16 v[144:159], v[124:127], v[104:107], v[144:159]
    ds_read_b128 v[236:239], v6 offset:3072
    v_cvt_pk_bf16_f32 v221, v58, v59
    v_cvt_pk_bf16_f32 v222, v60, v61
    v_cvt_pk_bf16_f32 v223, v62, v63
    s_waitcnt lgkmcnt(5)
    v_mfma_f32_32x32x16_bf16 v[48:63], v[176:179], v[224:227], 0
    s_bfe_u32 s61, s26, 524304
    v_lshl_add_u32 v248, s61, 13, v5
    s_bfe_u32 s62, s29, 524304
    v_lshl_add_u32 v251, s62, 13, v8
    s_waitcnt lgkmcnt(4)
    v_mfma_f32_32x32x16_bf16 v[48:63], v[180:183], v[228:231], v[48:63]
    v_xor_b32 v249, 64, v248
    v_xor_b32 v252, 32, v251
    v_mfma_f32_32x32x16_bf16 v[16:31], v[160:163], v[224:227], 0
    v_xor_b32 v253, 64, v251
    v_xor_b32 v254, 0x60, v251
    v_mfma_f32_32x32x16_bf16 v[16:31], v[164:167], v[228:231], v[16:31]
    s_waitcnt lgkmcnt(3)
    v_mfma_f32_32x32x16_bf16 v[48:63], v[216:219], v[240:243], v[48:63]
    s_waitcnt lgkmcnt(2)
    v_mfma_f32_32x32x16_bf16 v[48:63], v[220:223], v[244:247], v[48:63]
    v_mfma_f32_32x32x16_bf16 v[32:47], v[168:171], v[224:227], 0
    v_mfma_f32_32x32x16_bf16 v[32:47], v[172:175], v[228:231], v[32:47]
    ds_read_b64 v[2:3], v15 offset:128
    v_mfma_f32_32x32x16_bf16 v[16:31], v[200:203], v[240:243], v[16:31]
    ds_read_b128 v[224:227], v6 offset:6144
    s_nop 6
    v_cvt_pk_bf16_f32 v176, v48, v49
    v_cvt_pk_bf16_f32 v177, v50, v51
    v_cvt_pk_bf16_f32 v178, v52, v53
    v_cvt_pk_bf16_f32 v179, v54, v55
    v_mfma_f32_32x32x16_bf16 v[16:31], v[204:207], v[244:247], v[16:31]
    ds_read_b128 v[228:231], v6 offset:7168
    v_min_u32 v176, -2, v176
    v_min_u32 v177, -2, v177
    v_min_u32 v178, -2, v178
    v_min_u32 v179, -2, v179
    buffer_store_dwordx4 v[176:179], v13, s[52:55], s58 offen offset:0 sc1
    s_waitcnt lgkmcnt(2)
L_c_34:
    v_cmp_ne_u64 vcc, 0, v[2:3]
    s_cbranch_vccz L_c_34_ok
    ds_read_b64 v[2:3], v15 offset:128
    s_add_i32 s78, s78, -1
    s_cmp_gt_i32 s78, 0
    s_waitcnt lgkmcnt(0)
    s_cbranch_scc1 L_c_34
L_c_34_ok:
    ds_append v12 offset:528
    ds_read_b128 v[112:115], v251
    ds_read_b64_tr_b16 v[64:65], v248 offset:0
    v_mfma_f32_32x32x16_bf16 v[32:47], v[208:211], v[240:243], v[32:47]
    ds_read_b64_tr_b16 v[66:67], v248 offset:512
    ds_read_b64_tr_b16 v[68:69], v249 offset:0
    ds_read_b64_tr_b16 v[70:71], v249 offset:512
    v_cvt_pk_bf16_f32 v180, v56, v57
    v_cvt_pk_bf16_f32 v181, v58, v59
    v_mfma_f32_32x32x16_bf16 v[32:47], v[212:215], v[244:247], v[32:47]
    ds_read_b128 v[116:119], v252
    ds_read_b64_tr_b16 v[76:77], v248 offset:2048
    v_cvt_pk_bf16_f32 v182, v60, v61
    v_cvt_pk_bf16_f32 v183, v62, v63
    v_mfma_f32_32x32x16_bf16 v[16:31], v[184:187], v[232:235], v[16:31]
    ds_read_b64_tr_b16 v[78:79], v248 offset:2560
    ds_read_b64_tr_b16 v[80:81], v249 offset:2048
    v_min_u32 v180, -2, v180
    v_min_u32 v181, -2, v181
    v_mfma_f32_32x32x16_bf16 v[16:31], v[188:191], v[236:239], v[16:31]
    ds_read_b64_tr_b16 v[82:83], v249 offset:2560
    ds_read_b128 v[120:123], v253
    v_min_u32 v182, -2, v182
    v_mfma_f32_32x32x16_bf16 v[32:47], v[192:195], v[232:235], v[32:47]
    ds_read_b64_tr_b16 v[88:89], v248 offset:4096
    ds_read_b64_tr_b16 v[90:91], v248 offset:4608
    v_min_u32 v183, -2, v183
    v_mfma_f32_32x32x16_bf16 v[32:47], v[196:199], v[236:239], v[32:47]
    ds_read_b64_tr_b16 v[92:93], v249 offset:4096
    ds_read_b64_tr_b16 v[94:95], v249 offset:4608
    buffer_store_dwordx4 v[180:183], v13, s[52:55], s58 offen offset:256 sc1
    s_waitcnt lgkmcnt(12)
    v_mfma_f32_32x32x16_bf16 v[128:143], v[112:115], v[64:67], v[128:143]
    ds_read_b128 v[124:127], v254
    ds_read_b64_tr_b16 v[100:101], v248 offset:6144
    ds_read_b64_tr_b16 v[102:103], v248 offset:6656
    s_waitcnt lgkmcnt(13)
    v_mfma_f32_32x32x16_bf16 v[144:159], v[112:115], v[68:71], v[144:159]
    ds_read_b64_tr_b16 v[104:105], v249 offset:6144
    ds_read_b64_tr_b16 v[106:107], v249 offset:6656
    ds_read_b64 v[2:3], v15 offset:136
    s_waitcnt lgkmcnt(13)
    v_mfma_f32_32x32x16_bf16 v[128:143], v[116:119], v[76:79], v[128:143]
    s_bfe_u32 s61, s26, 524312
    v_lshl_add_u32 v248, s61, 13, v5
    s_bfe_u32 s62, s29, 524312
    v_lshl_add_u32 v251, s62, 13, v8
    v_xor_b32 v249, 64, v248
    s_waitcnt lgkmcnt(11)
    v_mfma_f32_32x32x16_bf16 v[144:159], v[116:119], v[80:83], v[144:159]
    v_xor_b32 v252, 32, v251
    v_xor_b32 v253, 64, v251
    v_xor_b32 v254, 0x60, v251
    s_waitcnt lgkmcnt(0)
L_c_35:
    v_cmp_ne_u64 vcc, 0, v[2:3]
    s_cbranch_vccz L_c_35_ok
    ds_read_b64 v[2:3], v15 offset:136
    s_add_i32 s78, s78, -1
    s_cmp_gt_i32 s78, 0
    s_waitcnt lgkmcnt(0)
    s_cbranch_scc1 L_c_35
L_c_35_ok:
    ds_read_b128 v[112:115], v251
    ds_read_b64_tr_b16 v[64:65], v248 offset:0
    v_mfma_f32_32x32x16_bf16 v[128:143], v[120:123], v[88:91], v[128:143]
    ds_read_b64_tr_b16 v[66:67], v248 offset:512
    ds_read_b64_tr_b16 v[68:69], v249 offset:0
    ds_read_b64_tr_b16 v[70:71], v249 offset:512
    ds_read_b128 v[116:119], v252
    v_mfma_f32_32x32x16_bf16 v[144:159], v[120:123], v[92:95], v[144:159]
    ds_read_b64_tr_b16 v[76:77], v248 offset:2048
    ds_read_b64_tr_b16 v[78:79], v248 offset:2560
    ds_read_b64_tr_b16 v[80:81], v249 offset:2048
    v_mfma_f32_32x32x16_bf16 v[128:143], v[124:127], v[100:103], v[128:143]
    ds_read_b64_tr_b16 v[82:83], v249 offset:2560
    ds_read_b128 v[120:123], v253
    ds_read_b64_tr_b16 v[88:89], v248 offset:4096
    v_mfma_f32_32x32x16_bf16 v[144:159], v[124:127], v[104:107], v[144:159]
    ds_read_b64_tr_b16 v[90:91], v248 offset:4608
    ds_read_b64_tr_b16 v[92:93], v249 offset:4096
    ds_read_b64_tr_b16 v[94:95], v249 offset:4608
    s_waitcnt lgkmcnt(12)
    v_mfma_f32_32x32x16_bf16 v[128:143], v[112:115], v[64:67], v[128:143]
    ds_read_b128 v[124:127], v254
    ds_read_b64_tr_b16 v[100:101], v248 offset:6144
    ds_read_b64_tr_b16 v[102:103], v248 offset:6656
    s_waitcnt lgkmcnt(13)
    v_mfma_f32_32x32x16_bf16 v[144:159], v[112:115], v[68:71], v[144:159]
    ds_read_b64_tr_b16 v[104:105], v249 offset:6144
    ds_read_b64_tr_b16 v[106:107], v249 offset:6656
    s_waitcnt lgkmcnt(12)
    v_mfma_f32_32x32x16_bf16 v[128:143], v[116:119], v[76:79], v[128:143]
    s_waitcnt lgkmcnt(10)
    v_mfma_f32_32x32x16_bf16 v[144:159], v[116:119], v[80:83], v[144:159]
    s_waitcnt lgkmcnt(7)
    v_mfma_f32_32x32x16_bf16 v[128:143], v[120:123], v[88:91], v[128:143]
    s_waitcnt lgkmcnt(2)
    v_mfma_f32_32x32x16_bf16 v[128:143], v[124:127], v[100:103], v[128:143]
    v_mfma_f32_32x32x16_bf16 v[144:159], v[120:123], v[92:95], v[144:159]
    s_waitcnt lgkmcnt(0)
    v_mfma_f32_32x32x16_bf16 v[144:159], v[124:127], v[104:107], v[144:159]
    s_nop 8
    v_cvt_pk_bf16_f32 v128, v128, v129
    v_cvt_pk_bf16_f32 v129, v130, v131
    v_cvt_pk_bf16_f32 v130, v132, v133
    v_cvt_pk_bf16_f32 v131, v134, v135
    v_cvt_pk_bf16_f32 v132, v136, v137
    v_cvt_pk_bf16_f32 v133, v138, v139
    v_cvt_pk_bf16_f32 v134, v140, v141
    v_cvt_pk_bf16_f32 v135, v142, v143
    v_mfma_f32_32x32x16_bf16 v[16:31], v[128:131], v[224:227], v[16:31]
    v_cvt_pk_bf16_f32 v144, v144, v145
    v_cvt_pk_bf16_f32 v145, v146, v147
    v_cvt_pk_bf16_f32 v146, v148, v149
    v_cvt_pk_bf16_f32 v147, v150, v151
    v_mfma_f32_32x32x16_bf16 v[16:31], v[132:135], v[228:231], v[16:31]
    v_cvt_pk_bf16_f32 v148, v152, v153
    v_cvt_pk_bf16_f32 v149, v154, v155
    v_cvt_pk_bf16_f32 v150, v156, v157
    v_cvt_pk_bf16_f32 v151, v158, v159
    v_mfma_f32_32x32x16_bf16 v[32:47], v[144:147], v[224:227], v[32:47]
    s_nop 0
    v_mfma_f32_32x32x16_bf16 v[32:47], v[148:151], v[228:231], v[32:47]
    s_nop 4
    v_cvt_pk_bf16_f32 v160, v16, v17
    v_cvt_pk_bf16_f32 v161, v18, v19
    v_cvt_pk_bf16_f32 v162, v20, v21
    v_cvt_pk_bf16_f32 v163, v22, v23
    v_min_u32 v160, -2, v160
    v_min_u32 v161, -2, v161
    v_min_u32 v162, -2, v162
    v_min_u32 v163, -2, v163
    buffer_store_dwordx4 v[160:163], v13, s[52:55], s57 offen offset:0 sc1
    v_cvt_pk_bf16_f32 v164, v24, v25
    v_cvt_pk_bf16_f32 v165, v26, v27
    v_cvt_pk_bf16_f32 v166, v28, v29
    v_cvt_pk_bf16_f32 v167, v30, v31
    v_min_u32 v164, -2, v164
    v_min_u32 v165, -2, v165
    v_min_u32 v166, -2, v166
    v_min_u32 v167, -2, v167
    buffer_store_dwordx4 v[164:167], v13, s[52:55], s57 offen offset:256 sc1
    v_cvt_pk_bf16_f32 v168, v32, v33
    v_cvt_pk_bf16_f32 v169, v34, v35
    v_cvt_pk_bf16_f32 v170, v36, v37
    v_cvt_pk_bf16_f32 v171, v38, v39
    v_min_u32 v168, -2, v168
    v_min_u32 v169, -2, v169
    v_min_u32 v170, -2, v170
    v_min_u32 v171, -2, v171
    buffer_store_dwordx4 v[168:171], v13, s[52:55], s57 offen offset:512 sc1
    v_cvt_pk_bf16_f32 v172, v40, v41
    v_cvt_pk_bf16_f32 v173, v42, v43
    v_cvt_pk_bf16_f32 v174, v44, v45
    v_cvt_pk_bf16_f32 v175, v46, v47
    v_min_u32 v172, -2, v172
    v_min_u32 v173, -2, v173
    v_min_u32 v174, -2, v174
    v_min_u32 v175, -2, v175
    buffer_store_dwordx4 v[172:175], v13, s[52:55], s57 offen offset:768 sc1
    s_lshl_b32 m0, s3, 2
    s_mov_b64 exec, 1
    buffer_load_dword v14, s[52:55], 0 offen offset:512 lds
    s_mov_b64 exec, -1
L_end:
    s_endpgm
.section .rodata,"a"
.p2align 6
.amdhsa_kernel standalone__mha_block_cached__near_ridge_kernel
  .amdhsa_next_free_vgpr 256
  .amdhsa_next_free_sgpr 102
  .amdhsa_accum_offset 256
  .amdhsa_group_segment_fixed_size 0
  .amdhsa_kernarg_size 64
  .amdhsa_user_sgpr_count 2
  .amdhsa_user_sgpr_kernarg_segment_ptr 1
  .amdhsa_system_sgpr_workgroup_id_x 1
.end_amdhsa_kernel
```
